```python
import torch

def _softmax(x, axis=-1):
    return torch.softmax(x, dim=axis)

def _gelu(x):
    return torch.nn.functional.gelu(x, approximate='tanh')

def _silu(x):
    return torch.nn.functional.silu(x)

def _sigmoid(x):
    return torch.sigmoid(x)

def _layernorm(x, axis=-1, eps=1e-05):
    m = x.mean(dim=axis, keepdim=True)
    v = x.var(dim=axis, keepdim=True, unbiased=False)
    return (x - m) / torch.sqrt(v + eps)

def _scatter_add(tgt, idx, src, axis=0):
    return tgt.clone().index_add_(axis, idx, src)

def _segment_sum(src, seg, n):
    out = torch.zeros((n,) + src.shape[1:], dtype=src.dtype)
    return out.index_add_(0, seg, src)

def _pad(x, pw):
    flat = tuple((v for pair in reversed(pw) for v in pair))
    return torch.nn.functional.pad(x, flat)
kernel_name = 'adaLN_cond__sliding_block_cached__glu_gated_glu__decode'

def setup_inputs():

    _w = lambda a: (lambda t: t.to(torch.bfloat16) if t.is_floating_point() else t)(torch.as_tensor(a))

    def _A_setup():
        B, Sq, D = (4, 1, 512)
        Hq, Hkv, Sk, Dh = (32, 8, 4096, 128)
        assert Hq % Hkv == 0, (Hq, Hkv)
        return {'x': _w((lambda *s: torch.randn(*s, dtype=torch.bfloat16) * 0.05)(B, Sq, D)), 'k_cache': _w((lambda *s: torch.randn(*s, dtype=torch.bfloat16) * 3.2)(B, Hkv, Sk, Dh)), 'v_cache': _w((lambda *s: torch.randn(*s, dtype=torch.bfloat16) * 0.4)(B, Hkv, Sk, Dh)), 'wq': _w((lambda *s: torch.randn(*s, dtype=torch.bfloat16) * 3.2)(D, Hq * Dh) * D ** (-0.5)), 'wo': _w((lambda *s: torch.randn(*s, dtype=torch.bfloat16) * 0.4)(Hq * Dh, D) * (Hq * Dh) ** (-0.5))}
    _A_in = _A_setup()

    def _B_setup():
        B, S, D, F = (4, 1, 512, 1792)
        return {'x': _w((lambda *s: torch.randn(*s, dtype=torch.bfloat16) * 0.05)(B, S, D)), 'w_gate': _w((lambda *s: torch.randn(*s, dtype=torch.bfloat16) * 0.05)(D, F)), 'w_up': _w((lambda *s: torch.randn(*s, dtype=torch.bfloat16) * 0.05)(D, F)), 'w_down': _w((lambda *s: torch.randn(*s, dtype=torch.bfloat16) * 0.05)(F, D))}
    _B_in = _B_setup()
    return {'A_x': _A_in['x'], 'A_k_cache': _A_in['k_cache'], 'A_v_cache': _A_in['v_cache'], 'A_wq': _A_in['wq'], 'A_wo': _A_in['wo'], 'B_x': _B_in['x'], 'B_w_gate': _B_in['w_gate'], 'B_w_up': _B_in['w_up'], 'B_w_down': _B_in['w_down'], 'c': _w((lambda *s: torch.randn(*s, dtype=torch.bfloat16) * 0.1)(4, 512) * 8.0), 'w_mod': _w((lambda *s: torch.randn(*s, dtype=torch.bfloat16) * 0.1)(512, 6 * 512) * 512 ** (-0.5) * 8.0)}

def reference(A_x, A_k_cache, A_v_cache, A_wq, A_wo, B_x, B_w_gate, B_w_up, B_w_down, c, w_mod):

    def _A_ref(x, k_cache, v_cache, wq, wo):
        B, Sq, D = x.shape
        Hq, Dh = (32, 128)
        Hkv, Sk = (k_cache.shape[1], k_cache.shape[2])
        W = min(4096, max(256, Sk // 4))
        rep = Hq // Hkv
        q = (lambda x, *d: x.permute(*d))((x @ wq).reshape(B, Sq, Hq, Dh), 0, 2, 1, 3)
        k = (lambda x, n, axis: torch.repeat_interleave(x, n, dim=axis))(k_cache[:, :, Sk - W:, :], rep, axis=1)
        v = (lambda x, n, axis: torch.repeat_interleave(x, n, dim=axis))(v_cache[:, :, Sk - W:, :], rep, axis=1)
        scores = torch.einsum('bhqd,bhkd->bhqk', q, k) * Dh ** (-0.5)
        p = _softmax(scores, axis=-1)
        o = torch.einsum('bhqk,bhkd->bhqd', p, v)
        return (lambda x, *d: x.permute(*d))(o, 0, 2, 1, 3).reshape(B, Sq, Hq * Dh) @ wo

    def _B_ref(x, w_gate, w_up, w_down):
        g = torch.einsum('bsd,df->bsf', x, w_gate)
        u = torch.einsum('bsd,df->bsf', x, w_up)
        h = _sigmoid(g) * u
        return torch.einsum('bsf,fd->bsd', h, w_down)
    x = A_x
    mod = (_silu(c) @ w_mod).reshape(c.shape[0], 6, 1, -1)
    sa, ca, ga, sb, cb, gb = (mod[:, 0].clone(), mod[:, 1].clone(), mod[:, 2].clone(), mod[:, 3].clone(), mod[:, 4].clone(), mod[:, 5].clone())
    h = _layernorm(x, axis=-1) * (1 + ca) + sa
    x = x + ga * _A_ref(h, A_k_cache, A_v_cache, A_wq, A_wo)
    h = _layernorm(x, axis=-1) * (1 + cb) + sb
    x = x + gb * _B_ref(h, B_w_gate, B_w_up, B_w_down)
    return x
```

```asm
; @launch grid=(256,1,1) block=(512,1,1) lds=134400
.amdgcn_target "amdgcn-amd-amdhsa--gfx950"
.text
.globl adaLN_cond__sliding_block_cached__glu_gated_glu__decode_kernel
.p2align 8
.type adaLN_cond__sliding_block_cached__glu_gated_glu__decode_kernel,@function
adaLN_cond__sliding_block_cached__glu_gated_glu__decode_kernel:
    s_cmp_ge_u32 s2, 256
    s_cbranch_scc1 L_end
    s_load_dwordx16 s[4:19], s[0:1], 0
    s_load_dwordx8 s[20:27], s[0:1], 64
    s_load_dwordx4 s[28:31], s[0:1], 96
    s_and_b32 s34, s2, 7
    s_lshr_b32 s35, s2, 3
    v_readfirstlane_b32 s33, v0
    v_and_b32 v1, 63, v0
    s_mov_b32 s36, 0
    s_getpc_b64 s[56:57]
L_pc:
    s_sub_u32 s56, s56, L_pc-adaLN_cond__sliding_block_cached__glu_gated_glu__decode_kernel
    s_subb_u32 s57, s57, 0
    s_mul_i32 s37, s35, 384
    v_lshlrev_b32 v2, 7, v0
    v_add_u32 v2, s37, v2
    v_cmp_gt_u32 vcc, 3, v0
    s_mov_b32 s38, 11256
    v_cmp_gt_u32 s[58:59], s38, v2
    s_and_b64 vcc, vcc, s[58:59]
    s_and_saveexec_b64 s[58:59], vcc
    s_cbranch_execz L_nopf
    global_load_dword v3, v2, s[56:57]
L_nopf:
    s_mov_b64 exec, s[58:59]
    s_lshr_b32 s33, s33, 6
    s_getreg_b32 s70, hwreg(HW_REG_XCC_ID, 0, 4)
    v_lshrrev_b32 v4, 4, v1
    v_and_b32 v5, 15, v1
    s_cmp_lt_u32 s35, 16
    s_cbranch_scc0 L_na
    s_lshr_b32 s56, s35, 2
    s_and_b32 s57, s35, 3
    s_lshl_b32 s37, s56, 3
    s_add_u32 s37, s37, s34
    s_lshl_b32 s37, s37, 12
    s_lshl_b32 s38, s57, 8
    s_add_u32 s37, s37, s38
    s_lshl_b32 s38, s33, 5
    s_add_u32 s37, s37, s38
    s_add_u32 s37, s37, 3072
    s_lshl_b32 s58, s37, 8
    s_add_u32 s59, s58, 4096
    v_xor_b32 v6, v5, v4
    v_lshlrev_b32 v6, 4, v6
    v_lshl_add_u32 v6, v4, 8, v6
    v_lshlrev_b32 v8, 1, v4
    v_xor_b32 v7, v5, v8
    v_lshlrev_b32 v7, 4, v7
    v_lshl_add_u32 v7, v4, 8, v7
    v_xor_b32 v9, 64, v6
    v_xor_b32 v10, 0x80, v6
    v_xor_b32 v11, 0xc0, v6
    v_xor_b32 v12, 0x80, v7
    s_lshl_b32 s39, s33, 13
    s_waitcnt lgkmcnt(0)
    s_mov_b32 s40, s30
    s_mov_b32 s41, s31
    s_mov_b32 s42, 4210688
    s_mov_b32 s43, 0x20000
    s_load_dword s32, s[30:31], 0
    s_mov_b32 s44, s6
    s_mov_b32 s45, s7
    s_mov_b32 s46, 33554432
    s_mov_b32 s47, 0x20000
    s_mov_b32 s48, s8
    s_mov_b32 s49, s9
    s_mov_b32 s50, 33554432
    s_mov_b32 s51, 0x20000
    s_cmp_eq_u32 s33, 0
    s_cbranch_scc1 L_att_gate
    s_branch L_att_nogate
L_att_gate:
    s_waitcnt lgkmcnt(0)
    s_add_u32 s32, s32, 0x9e3779b9
    s_mov_b32 s71, 1
    s_cmp_eq_u32 s33, 0
    s_cbranch_scc0 L_xt_1
    s_lshl_b32 s37, s34, 5
    s_add_u32 s37, s37, s35
    s_lshl_b32 s37, s37, 7
    s_add_u32 s37, s37, 3145728
    v_mov_b32 v16, s70
    v_mov_b32 v17, s32
    v_mov_b32 v18, 0
    s_mov_b64 exec, 1
    buffer_store_dwordx2 v[16:17], v18, s[40:43], s37 offen sc1
    s_mov_b64 exec, -1
L_xt_1:
    s_branch L_att_go
L_att_nogate:
    s_mov_b32 s71, 0
L_att_go:
    s_add_u32 m0, s39, 0
    s_nop 0
    buffer_load_dwordx4 v6, s[44:47], s58 offen offset:0 nt lds
    buffer_load_dwordx4 v9, s[44:47], s58 offen offset:1024 nt lds
    buffer_load_dwordx4 v10, s[44:47], s58 offen offset:2048 nt lds
    buffer_load_dwordx4 v11, s[44:47], s58 offen offset:3072 nt lds
    s_add_u32 m0, s39, 4096
    s_nop 0
    buffer_load_dwordx4 v6, s[44:47], s59 offen offset:0 nt lds
    buffer_load_dwordx4 v9, s[44:47], s59 offen offset:1024 nt lds
    buffer_load_dwordx4 v10, s[44:47], s59 offen offset:2048 nt lds
    buffer_load_dwordx4 v11, s[44:47], s59 offen offset:3072 nt lds
    s_add_u32 m0, s39, 65536
    s_nop 0
    buffer_load_dwordx4 v7, s[48:51], s58 offen offset:0 nt lds
    buffer_load_dwordx4 v12, s[48:51], s58 offen offset:1024 nt lds
    buffer_load_dwordx4 v7, s[48:51], s58 offen offset:2048 nt lds
    buffer_load_dwordx4 v12, s[48:51], s58 offen offset:3072 nt lds
    s_add_u32 m0, s39, 69632
    s_nop 0
    buffer_load_dwordx4 v7, s[48:51], s59 offen offset:0 nt lds
    buffer_load_dwordx4 v12, s[48:51], s59 offen offset:1024 nt lds
    buffer_load_dwordx4 v7, s[48:51], s59 offen offset:2048 nt lds
    buffer_load_dwordx4 v12, s[48:51], s59 offen offset:3072 nt lds
    s_mov_b32 s52, s4
    s_mov_b32 s53, s5
    s_mov_b32 s54, 4096
    s_mov_b32 s55, 0x20000
    s_mov_b32 s48, s12
    s_mov_b32 s49, s13
    s_mov_b32 s50, 4194304
    s_mov_b32 s51, 0x20000
    v_lshrrev_b32 v8, 2, v5
    v_and_b32 v9, 3, v5
    v_xor_b32 v10, v4, v9
    v_lshlrev_b32 v10, 4, v10
    v_lshl_add_u32 v10, v8, 6, v10
    v_lshl_add_u32 v10, v5, 8, v10
    v_add_u32 v16, s39, v10
    v_xor_b32 v17, 64, v16
    v_xor_b32 v18, 0x80, v16
    v_xor_b32 v19, 0xc0, v16
    v_lshl_add_u32 v10, v4, 2, v8
    v_and_b32 v11, 7, v10
    v_lshlrev_b32 v12, 5, v11
    v_lshl_add_u32 v12, v10, 8, v12
    v_lshl_add_u32 v12, v9, 3, v12
    v_add_u32 v20, s39, v12
    v_add_u32 v20, 65536, v20
    s_and_b32 s37, s33, 1
    s_lshl_b32 s37, s37, 2
    v_xor_b32 v11, s37, v11
    v_lshlrev_b32 v11, 5, v11
    v_lshl_add_u32 v11, v4, 13, v11
    v_lshl_add_u32 v11, v8, 10, v11
    v_lshl_add_u32 v11, v9, 3, v11
    s_lshr_b32 s37, s33, 1
    s_lshl_b32 s37, s37, 8
    s_add_u32 s37, s37, 4096
    v_add_u32 v142, s37, v11
    v_mul_u32_u24 v23, 320, v8
    v_lshl_add_u32 v23, v4, 4, v23
    v_add_u32 v23, 131072, v23
    v_lshlrev_b32 v141, 6, v8
    v_lshl_add_u32 v141, v4, 4, v141
    v_add_u32 v141, 132608, v141
    v_mul_u32_u24 v24, 144, v4
    v_add_u32 v24, v24, v5
    v_lshlrev_b32 v24, 2, v24
    v_add_u32 v24, s39, v24
    v_lshlrev_b32 v29, 4, v1
    s_and_b32 s37, s33, 1
    s_lshl_b32 s38, s37, 7
    v_xor_b32 v29, s38, v29
    s_lshl_b32 s38, s37, 6
    v_add_u32 v10, s38, v1
    s_lshr_b32 s37, s33, 1
    v_lshlrev_b32 v21, 3, v10
    s_mul_i32 s60, s37, 320
    s_add_u32 s60, s60, 131072
    v_lshl_add_u32 v22, v10, 1, s60
    s_mul_i32 s60, s37, 576
    v_lshl_add_u32 v25, v10, 2, s60
    v_and_b32 v11, 7, v1
    v_lshlrev_b32 v11, 5, v11
    s_lshl_b32 s60, s37, 3
    s_add_u32 s60, s60, 132352
    v_add_u32 v26, s60, v11
    v_lshrrev_b32 v11, 5, v1
    v_and_b32 v12, 30, v1
    v_lshlrev_b32 v13, 2, v12
    v_lshl_add_u32 v27, v11, 11, v13
    v_lshlrev_b32 v30, 3, v1
    v_lshlrev_b32 v31, 7, v4
    v_lshlrev_b32 v28, 7, v5
    v_lshlrev_b32 v12, 1, v5
    v_and_b32 v13, 0xffffffe3, v12
    v_and_b32 v14, 12, v12
    v_lshlrev_b32 v14, 1, v14
    v_or_b32 v13, v13, v14
    v_and_b32 v14, 16, v12
    v_lshrrev_b32 v14, 2, v14
    v_or_b32 v13, v13, v14
    s_lshl_b32 s38, s33, 6
    s_add_u32 s38, s38, 132608
    v_lshl_add_u32 v140, v13, 1, s38
    v_lshlrev_b32 v143, 15, v4
    v_lshl_add_u32 v143, v5, 4, v143
    s_lshl_b32 s38, s34, 2
    s_add_u32 s38, s38, s37
    s_lshl_b32 s60, s38, 4
    s_add_u32 s60, s60, s56
    s_lshl_b32 s60, s60, 10
    s_add_u32 s60, s60, 102400
    s_add_u32 s61, s60, 4096
    s_add_u32 s62, s60, 8192
    s_add_u32 s63, s60, 12288
    s_lshl_b32 s65, s38, 2
    s_add_u32 s65, s65, s56
    s_lshl_b32 s65, s65, 2
    s_add_u32 s65, s65, s57
    s_lshl_b32 s65, s65, 7
    s_add_u32 s65, s65, 888832
    s_lshl_b32 s64, s38, 1
    s_and_b32 s39, s33, 1
    s_add_u32 s64, s64, s39
    s_lshl_b32 s64, s64, 3
    s_add_u32 s64, s64, s56
    s_lshl_b32 s64, s64, 2
    s_add_u32 s64, s64, s57
    s_lshl_b32 s64, s64, 7
    s_add_u32 s64, s64, 626688
    s_lshl_b32 s67, s34, 4
    s_add_u32 s67, s67, s35
    s_lshl_b32 s68, s67, 11
    s_lshl_b32 s37, s33, 9
    s_add_u32 s68, s68, s37
    s_add_u32 s68, s68, 626688
    s_lshr_b32 s69, s67, 2
    s_lshl_b32 s69, s69, 11
    s_lshl_b32 s37, s33, 9
    s_add_u32 s69, s69, s37
    s_add_u32 s69, s69, 888832
    s_lshl_b32 s3, s34, 17
    s_lshr_b32 s37, s33, 1
    s_lshl_b32 s37, s37, 13
    s_add_u32 s3, s3, s37
    s_lshl_b32 s37, s35, 9
    s_add_u32 s3, s3, s37
    s_and_b32 s37, s33, 1
    s_lshl_b32 s37, s37, 8
    s_add_u32 s3, s3, s37
    s_add_u32 s3, s3, 954368
    s_lshl_b32 s66, s34, 12
    s_add_u32 s66, s66, 3145728
    s_mov_b32 s8, 0x22222222
    s_mov_b32 s9, 0x22222222
    s_mov_b32 s10, 0x44444444
    s_mov_b32 s11, 0x44444444
    s_mov_b32 s12, 0x88888888
    s_mov_b32 s13, 0x88888888
    s_cmp_eq_u32 s71, 1
    s_cbranch_scc1 L_att_tagged
    s_waitcnt lgkmcnt(0)
    s_add_u32 s32, s32, 0x9e3779b9
L_att_tagged:
    s_lshl_b32 s39, s67, 5
    s_lshl_b32 s58, s33, 2
    s_add_u32 s39, s39, s58
    s_lshl_b32 s58, s39, 10
    s_lshl_b32 s39, s33, 13
    s_add_u32 m0, s39, 4096
    v_xor_b32 v144, 32, v29
    v_xor_b32 v145, 64, v29
    v_xor_b32 v146, 96, v29
    s_waitcnt vmcnt(8)
    ds_read_b128 v[32:35], v16 offset:0
    ds_read_b128 v[36:39], v17 offset:0
    ds_read_b128 v[40:43], v18 offset:0
    ds_read_b128 v[44:47], v19 offset:0
    ds_read_b128 v[48:51], v16 offset:4096
    ds_read_b128 v[52:55], v17 offset:4096
    ds_read_b128 v[56:59], v18 offset:4096
    ds_read_b128 v[60:63], v19 offset:4096
    v_xor_b32 v9, 32, v20
    v_xor_b32 v10, 64, v20
    v_xor_b32 v11, 96, v20
    v_xor_b32 v12, 128, v20
    v_xor_b32 v13, 160, v20
    v_xor_b32 v14, 192, v20
    v_xor_b32 v15, 224, v20
    s_waitcnt lgkmcnt(0)
    v_bfe_u32 v8, v1, 4, 1
    v_lshl_add_u32 v8, v8, 6, v5
    s_and_b32 s37, s35, 3
    s_lshl_b32 s37, s37, 8
    v_lshl_add_u32 v8, v8, 1, s37
    s_lshr_b32 s37, s35, 2
    s_lshl_b32 s37, s37, 10
    buffer_load_ushort v164, v8, s[52:55], s37 offen offset:0
    buffer_load_ushort v165, v8, s[52:55], s37 offen offset:32
    buffer_load_ushort v166, v8, s[52:55], s37 offen offset:64
    buffer_load_ushort v167, v8, s[52:55], s37 offen offset:96
    s_lshl_b32 s37, s34, 17
    s_lshl_b32 s38, s35, 13
    s_add_u32 s37, s37, s38
    s_lshl_b32 s38, s33, 10
    s_add_u32 s37, s37, s38
    s_add_u32 s37, s37, 954368
    v_lshlrev_b32 v8, 4, v1
    buffer_load_dwordx4 v[152:155], v8, s[40:43], s37 offen sc1
    s_cmp_lt_u32 s33, 4
    s_cbranch_scc0 L_nopre
    buffer_load_dwordx2 v[156:157], v30, s[40:43], s68 offen sc1
    buffer_load_dwordx4 v[160:163], v31, s[40:43], s69 offen sc1
L_nopre:
    v_and_b32 v8, 7, v1
    v_lshlrev_b32 v8, 7, v8
    buffer_load_dwordx2 v[148:149], v8, s[40:43], s66 offen offset:3072 sc1
L_poll_2:
    buffer_load_dwordx2 v[124:125], v21, s[40:43], s60 offen sc1
    buffer_load_dwordx2 v[126:127], v21, s[40:43], s61 offen sc1
    buffer_load_dwordx2 v[128:129], v21, s[40:43], s62 offen sc1
    buffer_load_dwordx2 v[130:131], v21, s[40:43], s63 offen sc1
    buffer_load_dwordx2 v[132:133], v28, s[40:43], s66 offen sc1
    s_add_u32 s36, s36, 1
    s_cmp_gt_u32 s36, 400000
    s_cbranch_scc1 L_pollx_3
    s_waitcnt vmcnt(0)
    v_cmpx_eq_u32 vcc, s32, v125
    v_cmpx_eq_u32 vcc, s32, v127
    v_cmpx_eq_u32 vcc, s32, v129
    v_cmpx_eq_u32 vcc, s32, v131
    s_cmp_eq_u64 exec, -1
    s_mov_b64 exec, -1
    s_cbranch_scc0 L_poll_2
    s_branch L_pollx_3_ok
L_pollx_3:
    s_waitcnt vmcnt(0)
L_pollx_3_ok:
    v_add_f32 v124, v124, v126
    v_add_f32 v128, v128, v130
    v_add_f32 v124, v124, v128
    v_cvt_pk_bf16_f32 v124, v124, v124
    ds_write_b16 v22, v124
    buffer_load_dwordx4 v29, s[48:51], s58 offen offset:0 nt lds
    buffer_load_dwordx4 v144, s[48:51], s58 offen offset:1024 nt lds
    buffer_load_dwordx4 v145, s[48:51], s58 offen offset:2048 nt lds
    buffer_load_dwordx4 v146, s[48:51], s58 offen offset:3072 nt lds
    v_cmp_eq_u32 vcc, s70, v132
    v_cmp_eq_u32 s[38:39], s32, v133
    s_and_b64 vcc, vcc, s[38:39]
    s_cmp_eq_u64 vcc, -1
    s_cselect_b32 s71, 1, 0
    v_cmp_eq_u32 vcc, s70, v148
    v_cmp_eq_u32 s[38:39], s32, v149
    s_and_b64 vcc, vcc, s[38:39]
    s_cmp_eq_u64 vcc, -1
    s_cselect_b32 s22, 1, 0
    s_waitcnt lgkmcnt(0)
    s_barrier
    ds_read_b128 v[64:67], v23 offset:0
    ds_read_b128 v[68:71], v23 offset:64
    ds_read_b128 v[72:75], v23 offset:128
    ds_read_b128 v[76:79], v23 offset:192
    s_mov_b32 s37, 0x3db504f3
    s_mov_b32 s38, 1069066811
    s_waitcnt lgkmcnt(3)
    v_mfma_f32_16x16x32_bf16 v[112:115], v[32:35], v[64:67], 0
    v_mfma_f32_16x16x32_bf16 v[116:119], v[48:51], v[64:67], 0
    s_waitcnt lgkmcnt(2)
    v_mfma_f32_16x16x32_bf16 v[112:115], v[36:39], v[68:71], v[112:115]
    v_mfma_f32_16x16x32_bf16 v[116:119], v[52:55], v[68:71], v[116:119]
    s_waitcnt lgkmcnt(1)
    v_mfma_f32_16x16x32_bf16 v[112:115], v[40:43], v[72:75], v[112:115]
    v_mfma_f32_16x16x32_bf16 v[116:119], v[56:59], v[72:75], v[116:119]
    s_waitcnt lgkmcnt(0)
    v_mfma_f32_16x16x32_bf16 v[112:115], v[44:47], v[76:79], v[112:115]
    v_mfma_f32_16x16x32_bf16 v[116:119], v[60:63], v[76:79], v[116:119]
    ds_read_b64_tr_b16 v[80:81], v20 offset:0
    ds_read_b64_tr_b16 v[82:83], v20 offset:4096
    ds_read_b64_tr_b16 v[84:85], v9 offset:0
    ds_read_b64_tr_b16 v[86:87], v9 offset:4096
    ds_read_b64_tr_b16 v[88:89], v10 offset:0
    ds_read_b64_tr_b16 v[90:91], v10 offset:4096
    ds_read_b64_tr_b16 v[92:93], v11 offset:0
    ds_read_b64_tr_b16 v[94:95], v11 offset:4096
    ds_read_b64_tr_b16 v[96:97], v12 offset:0
    ds_read_b64_tr_b16 v[98:99], v12 offset:4096
    ds_read_b64_tr_b16 v[100:101], v13 offset:0
    ds_read_b64_tr_b16 v[102:103], v13 offset:4096
    ds_read_b64_tr_b16 v[104:105], v14 offset:0
    ds_read_b64_tr_b16 v[106:107], v14 offset:4096
    ds_read_b64_tr_b16 v[108:109], v15 offset:0
    ds_read_b64_tr_b16 v[110:111], v15 offset:4096
    v_cndmask_b32 v124, v112, v114, s[8:9]
    v_cndmask_b32 v125, v113, v115, s[8:9]
    v_cndmask_b32 v124, v124, v116, s[10:11]
    v_cndmask_b32 v125, v125, v117, s[10:11]
    v_cndmask_b32 v124, v124, v118, s[12:13]
    v_cndmask_b32 v125, v125, v119, s[12:13]
    v_cvt_pk_bf16_f32 v126, v124, v125
    v_and_b32 v125, 0xffff0000, v126
    v_lshlrev_b32 v124, 16, v126
    v_mul_f32 v124, s37, v124
    v_mul_f32 v125, s37, v125
    v_cvt_pk_bf16_f32 v126, v124, v125
    v_and_b32 v125, 0xffff0000, v126
    v_lshlrev_b32 v124, 16, v126
    v_max_f32 v127, v124, v125
    s_nop 1
    v_max_f32_dpp v127, v127, v127 quad_perm:[1,0,3,2] row_mask:0xf bank_mask:0xf
    s_nop 1
    v_max_f32_dpp v127, v127, v127 quad_perm:[2,3,0,1] row_mask:0xf bank_mask:0xf
    v_mov_b32 v126, v127
    s_nop 1
    v_permlane16_swap_b32 v127, v126
    v_max_f32 v127, v127, v126
    v_mov_b32 v126, v127
    s_nop 1
    v_permlane32_swap_b32 v127, v126
    v_max_f32 v127, v127, v126
    v_mul_f32 v126, s38, v127
    v_fma_f32 v124, v124, s38, -v126
    v_fma_f32 v125, v125, s38, -v126
    v_exp_f32 v124, v124
    v_exp_f32 v125, v125
    s_nop 0
    v_cvt_pk_bf16_f32 v129, v124, v125
    v_add_f32 v128, v124, v125
    s_nop 0
    v_mov_b32_dpp v120, v129 quad_perm:[0,0,0,0] row_mask:0xf bank_mask:0xf
    v_mov_b32_dpp v121, v129 quad_perm:[1,1,1,1] row_mask:0xf bank_mask:0xf
    v_mov_b32_dpp v122, v129 quad_perm:[2,2,2,2] row_mask:0xf bank_mask:0xf
    v_mov_b32_dpp v123, v129 quad_perm:[3,3,3,3] row_mask:0xf bank_mask:0xf
    s_waitcnt lgkmcnt(0)
    s_nop 0
    v_mfma_f32_16x16x32_bf16 v[32:35], v[120:123], v[80:83], 0
    v_mfma_f32_16x16x32_bf16 v[36:39], v[120:123], v[84:87], 0
    v_mfma_f32_16x16x32_bf16 v[40:43], v[120:123], v[88:91], 0
    v_mfma_f32_16x16x32_bf16 v[44:47], v[120:123], v[92:95], 0
    v_mfma_f32_16x16x32_bf16 v[48:51], v[120:123], v[96:99], 0
    v_mfma_f32_16x16x32_bf16 v[52:55], v[120:123], v[100:103], 0
    v_mfma_f32_16x16x32_bf16 v[56:59], v[120:123], v[104:107], 0
    v_mfma_f32_16x16x32_bf16 v[60:63], v[120:123], v[108:111], 0
    v_add_f32_dpp v128, v128, v128 quad_perm:[1,0,3,2] row_mask:0xf bank_mask:0xf
    v_lshrrev_b32 v8, 2, v5
    s_lshl_b32 s37, s33, 5
    v_add_f32_dpp v128, v128, v128 quad_perm:[2,3,0,1] row_mask:0xf bank_mask:0xf
    s_add_u32 s37, s37, 132352
    v_lshl_add_u32 v8, v8, 3, s37
    v_mov_b32 v126, v128
    s_nop 1
    v_permlane16_swap_b32 v128, v126
    v_add_f32 v128, v128, v126
    v_mov_b32 v126, v128
    s_nop 1
    v_permlane32_swap_b32 v128, v126
    v_add_f32 v128, v128, v126
    v_mov_b32 v10, v127
    v_mov_b32 v11, v128
    s_mov_b64 exec, 0x1111
    ds_write_b64 v8, v[10:11]
    s_mov_b64 exec, -1
    ds_write_b32 v24, v32 offset:0
    ds_write_b32 v24, v36 offset:64
    ds_write_b32 v24, v40 offset:128
    ds_write_b32 v24, v44 offset:192
    ds_write_b32 v24, v48 offset:256
    ds_write_b32 v24, v52 offset:320
    ds_write_b32 v24, v56 offset:384
    ds_write_b32 v24, v60 offset:448
    s_waitcnt lgkmcnt(0)
    s_barrier
    ds_read_b64 v[8:9], v26
    ds_read_b32 v132, v25 offset:0
    ds_read_b32 v133, v25 offset:8192
    ds_read_b32 v134, v25 offset:16384
    ds_read_b32 v135, v25 offset:24576
    ds_read_b32 v136, v25 offset:32768
    ds_read_b32 v137, v25 offset:40960
    ds_read_b32 v138, v25 offset:49152
    ds_read_b32 v139, v25 offset:57344
    v_mov_b32 v13, s32
    s_waitcnt lgkmcnt(8)
    v_max_f32_dpp v127, v8, v8 quad_perm:[1,0,3,2] row_mask:0xf bank_mask:0xf
    s_nop 1
    v_max_f32_dpp v127, v127, v127 quad_perm:[2,3,0,1] row_mask:0xf bank_mask:0xf
    s_nop 1
    v_max_f32_dpp v127, v127, v127 row_half_mirror row_mask:0xf bank_mask:0xf
    v_sub_f32 v8, v8, v127
    v_mul_f32 v8, s38, v8
    v_exp_f32 v8, v8
    s_nop 0
    v_mul_f32 v128, v8, v9
    v_readlane_b32 s14, v8, 0
    v_readlane_b32 s15, v8, 1
    v_readlane_b32 s16, v8, 2
    v_readlane_b32 s17, v8, 3
    v_readlane_b32 s18, v8, 4
    v_readlane_b32 s19, v8, 5
    v_readlane_b32 s20, v8, 6
    v_readlane_b32 s21, v8, 7
    v_add_f32_dpp v128, v128, v128 quad_perm:[1,0,3,2] row_mask:0xf bank_mask:0xf
    s_waitcnt lgkmcnt(0)
    v_mul_f32 v12, s14, v132
    v_add_f32_dpp v128, v128, v128 quad_perm:[2,3,0,1] row_mask:0xf bank_mask:0xf
    v_fmac_f32 v12, s15, v133
    s_nop 0
    v_add_f32_dpp v128, v128, v128 row_half_mirror row_mask:0xf bank_mask:0xf
    v_fmac_f32 v12, s16, v134
    v_fmac_f32 v12, s17, v135
    v_fmac_f32 v12, s18, v136
    v_fmac_f32 v12, s19, v137
    v_fmac_f32 v12, s20, v138
    v_fmac_f32 v12, s21, v139
    s_nop 1
    v_mov_b32_dpp v14, v12 quad_perm:[1,0,3,2] row_mask:0xf bank_mask:0xf
    v_cvt_pk_bf16_f32 v12, v12, v14
    s_cmp_eq_u32 s71, 0
    s_cbranch_scc1 L_rem_4
    s_mov_b32 exec_lo, 0x55555555
    s_mov_b32 exec_hi, 0x55555555
    buffer_store_dwordx2 v[12:13], v27, s[40:43], s64 offen
    s_mov_b64 exec, -1
    s_bitcmp1_b32 s33, 0
    s_cbranch_scc1 L_nost_6
    v_mov_b32 v8, v127
    v_mov_b32 v9, s32
    v_mov_b32 v10, v128
    v_mov_b32 v11, s32
    v_mov_b32 v14, 0
    s_mov_b64 exec, 1
    buffer_store_dwordx4 v[8:11], v14, s[40:43], s65 offen
    s_mov_b64 exec, -1
L_nost_6:
    s_branch L_pubx_5
L_rem_4:
    s_mov_b32 exec_lo, 0x55555555
    s_mov_b32 exec_hi, 0x55555555
    buffer_store_dwordx2 v[12:13], v27, s[40:43], s64 offen sc1
    s_mov_b64 exec, -1
    s_bitcmp1_b32 s33, 0
    s_cbranch_scc1 L_nost_7
    v_mov_b32 v8, v127
    v_mov_b32 v9, s32
    v_mov_b32 v10, v128
    v_mov_b32 v11, s32
    v_mov_b32 v14, 0
    s_mov_b64 exec, 1
    buffer_store_dwordx4 v[8:11], v14, s[40:43], s65 offen sc1
    s_mov_b64 exec, -1
L_nost_7:
L_pubx_5:
    s_waitcnt vmcnt(0)
    s_cmp_lt_u32 s33, 4
    s_cbranch_scc0 L_D_skip
L_poll_8:
    buffer_load_dwordx2 v[124:125], v30, s[40:43], s68 offen sc1
    buffer_load_dwordx4 v[128:131], v31, s[40:43], s69 offen sc1
    s_add_u32 s36, s36, 1
    s_cmp_gt_u32 s36, 400000
    s_cbranch_scc1 L_pollx_9
    s_waitcnt vmcnt(0)
    v_cmpx_eq_u32 vcc, s32, v125
    v_cmpx_eq_u32 vcc, s32, v129
    v_cmpx_eq_u32 vcc, s32, v131
    s_cmp_eq_u64 exec, -1
    s_mov_b64 exec, -1
    s_cbranch_scc0 L_poll_8
    s_branch L_pollx_9_ok
L_pollx_9:
    s_waitcnt vmcnt(0)
L_pollx_9_ok:
    v_mov_b32 v132, v128
    v_mov_b32 v135, v128
    v_and_b32 v127, 0xffff0000, v124
    v_lshlrev_b32 v126, 16, v124
    v_permlane16_swap_b32 v132, v135
    v_max_f32 v132, v132, v135
    v_mov_b32 v135, v132
    s_nop 1
    v_permlane32_swap_b32 v132, v135
    v_max_f32 v132, v132, v135
    v_sub_f32 v133, v128, v132
    v_mul_f32 v133, s38, v133
    v_exp_f32 v133, v133
    s_nop 0
    v_mul_f32 v134, v133, v130
    v_mul_f32 v126, v133, v126
    v_mul_f32 v127, v133, v127
    v_mov_b32 v136, v134
    v_mov_b32 v137, v126
    v_mov_b32 v138, v127
    v_permlane16_swap_b32 v134, v136
    v_permlane16_swap_b32 v126, v137
    v_permlane16_swap_b32 v127, v138
    v_add_f32 v134, v134, v136
    v_add_f32 v126, v126, v137
    v_add_f32 v127, v127, v138
    v_mov_b32 v136, v134
    v_mov_b32 v137, v126
    v_mov_b32 v138, v127
    v_permlane32_swap_b32 v134, v136
    v_permlane32_swap_b32 v126, v137
    v_permlane32_swap_b32 v127, v138
    v_add_f32 v134, v134, v136
    v_add_f32 v126, v126, v137
    v_rcp_f32 v134, v134
    v_add_f32 v127, v127, v138
    v_mul_f32 v126, v126, v134
    v_mul_f32 v127, v127, v134
    v_cvt_pk_bf16_f32 v124, v126, v127
    s_mov_b64 exec, 0xffff
    ds_write_b32 v140, v124
    s_mov_b64 exec, -1
L_D_skip:
    s_waitcnt vmcnt(0) lgkmcnt(0)
    s_barrier
    ds_read_b128 v[124:127], v141
    ds_read_b64_tr_b16 v[32:33], v142 offset:0
    ds_read_b64_tr_b16 v[34:35], v142 offset:32768
    v_xor_b32 v9, 32, v142
    ds_read_b64_tr_b16 v[36:37], v9 offset:0
    ds_read_b64_tr_b16 v[38:39], v9 offset:32768
    v_xor_b32 v10, 64, v142
    ds_read_b64_tr_b16 v[40:41], v10 offset:0
    ds_read_b64_tr_b16 v[42:43], v10 offset:32768
    v_xor_b32 v11, 96, v142
    ds_read_b64_tr_b16 v[44:45], v11 offset:0
    ds_read_b64_tr_b16 v[46:47], v11 offset:32768
    v_mov_b32 v133, s32
    s_waitcnt lgkmcnt(6)
    v_mfma_f32_16x16x32_bf16 v[64:67], v[124:127], v[32:35], 0
    s_waitcnt lgkmcnt(4)
    v_mfma_f32_16x16x32_bf16 v[68:71], v[124:127], v[36:39], 0
    s_waitcnt lgkmcnt(2)
    v_mfma_f32_16x16x32_bf16 v[72:75], v[124:127], v[40:43], 0
    s_waitcnt lgkmcnt(0)
    v_mfma_f32_16x16x32_bf16 v[76:79], v[124:127], v[44:47], 0
    v_mov_b32 v135, s32
    s_nop 2
    v_cvt_pk_bf16_f32 v132, v64, v68
    s_nop 2
    v_cvt_pk_bf16_f32 v134, v72, v76
    s_cmp_eq_u32 s71, 0
    s_cbranch_scc1 L_rem_10
    buffer_store_dwordx4 v[132:135], v143, s[40:43], s3 offen
    s_branch L_pubx_11
L_rem_10:
    buffer_store_dwordx4 v[132:135], v143, s[40:43], s3 offen sc1
L_pubx_11:
    v_lshlrev_b32 v7, 4, v1
    s_lshl_b32 s58, s34, 17
    s_lshl_b32 s39, s35, 13
    s_add_u32 s58, s58, s39
    s_lshl_b32 s39, s33, 10
    s_add_u32 s58, s58, s39
    s_add_u32 s58, s58, 954368
    s_lshr_b32 s37, s35, 2
    s_and_b32 s38, s35, 3
    s_lshl_b32 s57, s37, 10
    v_and_b32 v8, 31, v1
    v_lshlrev_b32 v14, 4, v8
    s_lshl_b32 s39, s33, 9
    s_add_u32 s39, s39, 65536
    v_add_u32 v18, s39, v14
    v_lshrrev_b32 v13, 5, v1
    s_lshl_b32 s64, s35, 12
    s_add_u32 s64, s64, 2002944
    s_lshl_b32 s39, s34, 9
    s_add_u32 s63, s64, s39
    s_lshl_b32 s39, s33, 10
    s_add_u32 s64, s64, s39
    v_lshl_add_u32 v19, v13, 11, v14
    v_add_u32 v19, 65536, v19
    s_waitcnt vmcnt(0)
L_poll_12:
    buffer_load_dwordx4 v[32:35], v7, s[40:43], s58 offen sc1
    s_add_u32 s36, s36, 1
    s_cmp_gt_u32 s36, 400000
    s_cbranch_scc1 L_pollx_13
    s_waitcnt vmcnt(0)
    v_cmpx_eq_u32 vcc, s32, v33
    v_cmpx_eq_u32 vcc, s32, v35
    s_cmp_eq_u64 exec, -1
    s_mov_b64 exec, -1
    s_cbranch_scc0 L_poll_12
    s_branch L_pollx_13_ok
L_pollx_13:
    s_waitcnt vmcnt(0)
L_pollx_13_ok:
    v_lshlrev_b32 v40, 16, v32
    v_and_b32 v41, 0xffff0000, v32
    v_lshlrev_b32 v42, 16, v34
    v_and_b32 v43, 0xffff0000, v34
    v_mov_b32 v44, v40
    v_mov_b32 v45, v41
    v_mov_b32 v46, v42
    v_mov_b32 v47, v43
    v_permlane32_swap_b32 v40, v44
    v_permlane32_swap_b32 v41, v45
    v_permlane32_swap_b32 v42, v46
    v_permlane32_swap_b32 v43, v47
    v_add_f32 v40, v40, v44
    v_add_f32 v41, v41, v45
    v_add_f32 v42, v42, v46
    v_add_f32 v43, v43, v47
    s_mov_b32 exec_hi, 0
    ds_write_b128 v18, v[40:43]
    s_mov_b32 exec_hi, -1
    s_mov_b32 s16, 0xaaaaaaaa
    s_mov_b32 s17, 0xaaaaaaaa
    v_lshrrev_b32 v9, 4, v8
    v_lshl_add_u32 v10, v9, 6, v5
    v_lshrrev_b32 v16, 1, v10
    v_lshlrev_b32 v16, 3, v16
    s_lshl_b32 s60, s37, 11
    s_lshl_b32 s39, s38, 9
    s_add_u32 s60, s60, s39
    s_lshl_b32 s62, s34, 13
    s_add_u32 s62, s62, s60
    s_add_u32 s62, s62, 2068480
    s_add_u32 s60, s60, 69632
    s_waitcnt lgkmcnt(0)
    s_barrier
    s_cmp_eq_u32 s33, 0
    s_cbranch_scc0 L_end
    ds_read_b128 v[48:51], v19 offset:0
    ds_read_b128 v[52:55], v19 offset:512
    ds_read_b128 v[56:59], v19 offset:1024
    ds_read_b128 v[60:63], v19 offset:1536
    v_mov_b32 v37, s32
    v_mov_b32 v39, s32
    s_waitcnt lgkmcnt(2)
    v_add_f32 v48, v48, v52
    v_add_f32 v49, v49, v53
    v_add_f32 v50, v50, v54
    v_add_f32 v51, v51, v55
    s_waitcnt lgkmcnt(0)
    v_add_f32 v56, v56, v60
    v_add_f32 v57, v57, v61
    v_add_f32 v58, v58, v62
    v_add_f32 v59, v59, v63
    v_add_f32 v40, v48, v56
    v_add_f32 v41, v49, v57
    v_add_f32 v42, v50, v58
    v_add_f32 v43, v51, v59
    v_mov_b32 v44, v40
    v_mov_b32 v45, v41
    v_mov_b32 v46, v42
    v_mov_b32 v47, v43
    v_permlane32_swap_b32 v40, v44
    v_permlane32_swap_b32 v41, v45
    v_permlane32_swap_b32 v42, v46
    v_permlane32_swap_b32 v43, v47
    v_add_f32 v40, v40, v44
    v_add_f32 v41, v41, v45
    v_add_f32 v42, v42, v46
    v_add_f32 v43, v43, v47
    v_cvt_pk_bf16_f32 v36, v40, v41
    v_cvt_pk_bf16_f32 v38, v42, v43
    s_mov_b32 exec_hi, 0
    buffer_store_dwordx4 v[36:39], v7, s[40:43], s63 offen sc1
    s_mov_b32 exec_hi, -1
    s_lshl_b32 s64, s35, 12
    s_add_u32 s64, s64, 2002944
    v_lshrrev_b32 v11, 2, v5
    v_lshlrev_b32 v11, 2, v11
    v_lshl_add_u32 v11, v9, 5, v11
    v_bfe_u32 v12, v5, 1, 1
    v_add_u32 v11, v11, v12
    v_lshlrev_b32 v17, 3, v11
    s_lshl_b32 s56, s37, 3
    s_lshl_b32 s39, s38, 1
    s_add_u32 s56, s56, s39
    s_lshr_b32 s39, s34, 2
    s_add_u32 s56, s56, s39
    s_lshl_b32 s56, s56, 2
    s_and_b32 s61, s34, 3
    s_add_u32 s56, s56, s61
    s_mul_i32 s59, s56, 3584
    s_add_u32 s59, s59, 2134016
    s_lshl_b32 s39, s39, 4
    s_lshl_b32 s61, s61, 2
    s_add_u32 s39, s39, s61
    v_lshrrev_b32 v11, 2, v5
    v_and_b32 v12, 3, v5
    v_add_u32 v10, s39, v12
    v_lshlrev_b32 v10, 4, v10
    v_lshl_add_u32 v19, v11, 2, v10
    v_add_u32 v19, 72704, v19
    s_lshr_b32 s39, s34, 2
    s_lshl_b32 s39, s39, 6
    s_add_u32 s39, s39, s61
    s_lshl_b32 s61, s38, 7
    s_add_u32 s39, s39, s61
    v_lshl_add_u32 v9, v11, 4, v12
    v_add_u32 v9, s39, v9
    v_lshlrev_b32 v6, 1, v9
    v_lshrrev_b32 v9, 1, v9
    v_lshlrev_b32 v22, 3, v9
    s_lshl_b32 s61, s37, 11
    s_add_u32 s61, s61, 94208
    v_add_u32 v18, 72704, v14
    s_mov_b32 s14, 0x00003f80
    s_mov_b32 s15, 0x3f800000
L_poll_14:
    buffer_load_dwordx2 v[96:97], v16, s[40:43], s60 offen offset:0 sc1
    buffer_load_dwordx2 v[98:99], v16, s[40:43], s60 offen offset:64 sc1
    buffer_load_dwordx2 v[100:101], v16, s[40:43], s60 offen offset:128 sc1
    buffer_load_dwordx2 v[102:103], v16, s[40:43], s60 offen offset:192 sc1
    s_add_u32 s36, s36, 1
    s_cmp_gt_u32 s36, 400000
    s_cbranch_scc1 L_pollx_15
    s_waitcnt vmcnt(0)
    v_cmpx_eq_u32 vcc, s32, v97
    v_cmpx_eq_u32 vcc, s32, v99
    v_cmpx_eq_u32 vcc, s32, v101
    v_cmpx_eq_u32 vcc, s32, v103
    s_cmp_eq_u64 exec, -1
    s_mov_b64 exec, -1
    s_cbranch_scc0 L_poll_14
    s_branch L_pollx_15_ok
L_pollx_15:
    s_waitcnt vmcnt(0)
L_pollx_15_ok:
    v_lshlrev_b32 v104, 16, v96
    v_and_b32 v108, 0xffff0000, v96
    v_cndmask_b32 v104, v104, v108, s[16:17]
    v_lshlrev_b32 v105, 16, v98
    v_and_b32 v109, 0xffff0000, v98
    v_cndmask_b32 v105, v105, v109, s[16:17]
    v_lshlrev_b32 v106, 16, v100
    v_and_b32 v110, 0xffff0000, v100
    v_cndmask_b32 v106, v106, v110, s[16:17]
    v_lshlrev_b32 v107, 16, v102
    v_and_b32 v111, 0xffff0000, v102
    v_cndmask_b32 v107, v107, v111, s[16:17]
    v_lshlrev_b32 v24, 16, v164
    v_lshlrev_b32 v25, 16, v165
    v_lshlrev_b32 v26, 16, v166
    v_lshlrev_b32 v27, 16, v167
L_poll_16:
    buffer_load_dwordx4 v[32:35], v7, s[40:43], s64 offen offset:0 sc1
    buffer_load_dwordx4 v[36:39], v7, s[40:43], s64 offen offset:1024 sc1
    buffer_load_dwordx4 v[40:43], v7, s[40:43], s64 offen offset:2048 sc1
    buffer_load_dwordx4 v[44:47], v7, s[40:43], s64 offen offset:3072 sc1
    s_add_u32 s36, s36, 1
    s_cmp_gt_u32 s36, 400000
    s_cbranch_scc1 L_pollx_17
    s_waitcnt vmcnt(0)
    v_cmpx_eq_u32 vcc, s32, v33
    v_cmpx_eq_u32 vcc, s32, v35
    v_cmpx_eq_u32 vcc, s32, v37
    v_cmpx_eq_u32 vcc, s32, v39
    v_cmpx_eq_u32 vcc, s32, v41
    v_cmpx_eq_u32 vcc, s32, v43
    v_cmpx_eq_u32 vcc, s32, v45
    v_cmpx_eq_u32 vcc, s32, v47
    s_cmp_eq_u64 exec, -1
    s_mov_b64 exec, -1
    s_cbranch_scc0 L_poll_16
    s_branch L_pollx_17_ok
L_pollx_17:
    s_waitcnt vmcnt(0)
L_pollx_17_ok:
    v_lshlrev_b32 v48, 16, v32
    v_and_b32 v49, 0xffff0000, v32
    v_lshlrev_b32 v50, 16, v34
    v_and_b32 v51, 0xffff0000, v34
    v_dot2c_f32_bf16 v48, s14, v36
    v_dot2c_f32_bf16 v49, s15, v36
    v_dot2c_f32_bf16 v50, s14, v38
    v_dot2c_f32_bf16 v51, s15, v38
    v_dot2c_f32_bf16 v48, s14, v40
    v_dot2c_f32_bf16 v49, s15, v40
    v_dot2c_f32_bf16 v50, s14, v42
    v_dot2c_f32_bf16 v51, s15, v42
    v_dot2c_f32_bf16 v48, s14, v44
    v_dot2c_f32_bf16 v49, s15, v44
    v_dot2c_f32_bf16 v50, s14, v46
    v_dot2c_f32_bf16 v51, s15, v46
    v_mov_b32 v32, v48
    v_mov_b32 v33, v49
    v_mov_b32 v34, v50
    v_mov_b32 v35, v51
    v_permlane32_swap_b32 v48, v32
    v_permlane32_swap_b32 v49, v33
    v_permlane32_swap_b32 v50, v34
    v_permlane32_swap_b32 v51, v35
    v_add_f32 v48, v48, v32
    v_add_f32 v49, v49, v33
    v_add_f32 v50, v50, v34
    v_add_f32 v51, v51, v35
    v_cvt_pk_bf16_f32 v32, v48, v49
    v_and_b32 v49, 0xffff0000, v32
    v_lshlrev_b32 v48, 16, v32
    v_cvt_pk_bf16_f32 v33, v50, v51
    v_and_b32 v51, 0xffff0000, v33
    v_lshlrev_b32 v50, 16, v33
    v_mul_f32 v48, v48, v104
    v_mul_f32 v49, v49, v105
    v_mul_f32 v50, v50, v106
    v_mul_f32 v51, v51, v107
    v_cvt_pk_bf16_f32 v32, v48, v49
    v_and_b32 v49, 0xffff0000, v32
    v_lshlrev_b32 v48, 16, v32
    v_cvt_pk_bf16_f32 v33, v50, v51
    v_and_b32 v51, 0xffff0000, v33
    v_lshlrev_b32 v50, 16, v33
    v_add_f32 v48, v48, v24
    v_add_f32 v49, v49, v25
    v_add_f32 v50, v50, v26
    v_add_f32 v51, v51, v27
    v_cvt_pk_bf16_f32 v32, v48, v49
    v_and_b32 v25, 0xffff0000, v32
    v_lshlrev_b32 v24, 16, v32
    v_cvt_pk_bf16_f32 v33, v50, v51
    v_and_b32 v27, 0xffff0000, v33
    v_lshlrev_b32 v26, 16, v33
    v_mov_b32_dpp v32, v24 quad_perm:[1,0,3,2] row_mask:0xf bank_mask:0xf
    v_mov_b32_dpp v33, v25 quad_perm:[1,0,3,2] row_mask:0xf bank_mask:0xf
    v_mov_b32_dpp v34, v26 quad_perm:[1,0,3,2] row_mask:0xf bank_mask:0xf
    v_mov_b32_dpp v35, v27 quad_perm:[1,0,3,2] row_mask:0xf bank_mask:0xf
    v_cvt_pk_bf16_f32 v40, v24, v32
    v_mov_b32 v41, s32
    v_cvt_pk_bf16_f32 v42, v25, v33
    v_mov_b32 v43, s32
    v_cvt_pk_bf16_f32 v44, v26, v34
    v_mov_b32 v45, s32
    v_cvt_pk_bf16_f32 v46, v27, v35
    v_mov_b32 v47, s32
    s_cmp_eq_u32 s22, 0
    s_cbranch_scc1 L_rem_18
    s_mov_b32 exec_lo, 0x55555555
    s_mov_b32 exec_hi, 0
    buffer_store_dwordx2 v[40:41], v17, s[40:43], s62 offen offset:0
    buffer_store_dwordx2 v[42:43], v17, s[40:43], s62 offen offset:16
    buffer_store_dwordx2 v[44:45], v17, s[40:43], s62 offen offset:128
    buffer_store_dwordx2 v[46:47], v17, s[40:43], s62 offen offset:144
    s_mov_b64 exec, -1
    s_branch L_pubx_19
L_rem_18:
    s_mov_b32 exec_lo, 0x55555555
    s_mov_b32 exec_hi, 0
    buffer_store_dwordx2 v[40:41], v17, s[40:43], s62 offen offset:0 sc1
    buffer_store_dwordx2 v[42:43], v17, s[40:43], s62 offen offset:16 sc1
    buffer_store_dwordx2 v[44:45], v17, s[40:43], s62 offen offset:128 sc1
    buffer_store_dwordx2 v[46:47], v17, s[40:43], s62 offen offset:144 sc1
    s_mov_b64 exec, -1
L_pubx_19:
    s_mov_b32 exec_hi, 0
    ds_write_b128 v18, v[24:27]
    s_mov_b32 exec_hi, -1
    s_waitcnt lgkmcnt(0)
    ds_read_b32 v24, v19
    s_mov_b32 s44, s26
    s_mov_b32 s45, s27
    s_mov_b32 s46, 4096
    s_mov_b32 s47, 0x20000
L_poll_20:
    buffer_load_dwordx2 v[20:21], v22, s[40:43], s61 offen sc1
    s_add_u32 s36, s36, 1
    s_cmp_gt_u32 s36, 400000
    s_cbranch_scc1 L_pollx_21
    s_waitcnt vmcnt(0)
    v_cmpx_eq_u32 vcc, s32, v21
    s_cmp_eq_u64 exec, -1
    s_mov_b64 exec, -1
    s_cbranch_scc0 L_poll_20
    s_branch L_pollx_21_ok
L_pollx_21:
    s_waitcnt vmcnt(0)
L_pollx_21_ok:
    v_lshlrev_b32 v25, 16, v20
    v_and_b32 v26, 0xffff0000, v20
    v_cndmask_b32 v25, v25, v26, s[16:17]
    v_mov_b32 v44, 0
    v_mov_b32 v45, s32
    v_mov_b32 v46, 0
    v_mov_b32 v47, s32
    s_waitcnt lgkmcnt(0)
L_poll_22:
    buffer_load_dwordx4 v[32:35], v7, s[40:43], s59 offen offset:0 sc1
    buffer_load_dwordx4 v[36:39], v7, s[40:43], s59 offen offset:1024 sc1
    buffer_load_dwordx4 v[40:43], v7, s[40:43], s59 offen offset:2048 sc1
    s_mov_b32 exec_hi, 0
    buffer_load_dwordx4 v[44:47], v7, s[40:43], s59 offen offset:3072 sc1
    s_mov_b32 exec_hi, -1
    s_add_u32 s36, s36, 1
    s_cmp_gt_u32 s36, 400000
    s_cbranch_scc1 L_pollx_23
    s_waitcnt vmcnt(0)
    v_cmpx_eq_u32 vcc, s32, v33
    v_cmpx_eq_u32 vcc, s32, v35
    v_cmpx_eq_u32 vcc, s32, v37
    v_cmpx_eq_u32 vcc, s32, v39
    v_cmpx_eq_u32 vcc, s32, v41
    v_cmpx_eq_u32 vcc, s32, v43
    v_cmpx_eq_u32 vcc, s32, v45
    v_cmpx_eq_u32 vcc, s32, v47
    s_cmp_eq_u64 exec, -1
    s_mov_b64 exec, -1
    s_cbranch_scc0 L_poll_22
    s_branch L_pollx_23_ok
L_pollx_23:
    s_waitcnt vmcnt(0)
L_pollx_23_ok:
    v_lshlrev_b32 v48, 16, v32
    v_and_b32 v49, 0xffff0000, v32
    v_lshlrev_b32 v50, 16, v34
    v_and_b32 v51, 0xffff0000, v34
    v_dot2c_f32_bf16 v48, s14, v36
    v_dot2c_f32_bf16 v49, s15, v36
    v_dot2c_f32_bf16 v50, s14, v38
    v_dot2c_f32_bf16 v51, s15, v38
    v_dot2c_f32_bf16 v48, s14, v40
    v_dot2c_f32_bf16 v49, s15, v40
    v_dot2c_f32_bf16 v50, s14, v42
    v_dot2c_f32_bf16 v51, s15, v42
    v_dot2c_f32_bf16 v48, s14, v44
    v_dot2c_f32_bf16 v49, s15, v44
    v_dot2c_f32_bf16 v50, s14, v46
    v_dot2c_f32_bf16 v51, s15, v46
    v_add_f32_dpp v32, v48, v48 row_shl:8 row_mask:0xf bank_mask:0x3
    v_add_f32_dpp v33, v49, v49 row_shl:8 row_mask:0xf bank_mask:0x3
    v_add_f32_dpp v32, v50, v50 row_shr:8 row_mask:0xf bank_mask:0xc
    v_add_f32_dpp v33, v51, v51 row_shr:8 row_mask:0xf bank_mask:0xc
    s_nop 0
    v_add_f32_dpp v34, v32, v32 row_shl:4 row_mask:0xf bank_mask:0x5
    v_add_f32_dpp v34, v33, v33 row_shr:4 row_mask:0xf bank_mask:0xa
    v_mov_b32 v35, v34
    s_nop 1
    v_permlane16_swap_b32 v34, v35
    v_add_f32 v34, v34, v35
    v_mov_b32 v35, v34
    s_nop 1
    v_permlane32_swap_b32 v34, v35
    v_add_f32 v34, v34, v35
    v_cvt_pk_bf16_f32 v32, v34, v34
    v_lshlrev_b32 v32, 16, v32
    v_mul_f32 v32, v32, v25
    v_cvt_pk_bf16_f32 v32, v32, v32
    v_lshlrev_b32 v32, 16, v32
    v_add_f32 v32, v32, v24
    s_nop 1
    v_mov_b32_dpp v34, v32 quad_perm:[1,0,3,2] row_mask:0xf bank_mask:0xf
    v_cvt_pk_bf16_f32 v32, v32, v34
    s_mov_b64 exec, 0x5555
    buffer_store_dword v32, v6, s[44:47], s57 offen
    s_cmp_eq_u32 s56, 0
    s_cbranch_scc0 L_att_done
    s_mov_b64 exec, 1
    v_mov_b32 v33, s32
    v_mov_b32 v34, 0
    buffer_store_dword v33, v34, s[40:43], 0 offen offset:0 sc1
L_att_done:
    s_endpgm
L_na:
    s_sub_u32 s56, s35, 16
    s_lshr_b32 s57, s56, 2
    s_lshl_b32 s37, s34, 2
    s_add_u32 s57, s57, s37
    s_and_b32 s58, s56, 3
    s_cmp_lt_u32 s34, 4
    s_cselect_b32 s63, 1, 0
    s_cmp_lt_u32 s56, 8
    s_cselect_b32 s63, s63, 0
    v_lshlrev_b32 v35, 3, v1
    s_lshr_b32 s37, s33, 1
    s_lshl_b32 s59, s37, 10
    v_lshlrev_b32 v8, 4, v1
    s_and_b32 s38, s33, 1
    s_lshl_b32 s38, s38, 6
    v_add_u32 v9, s38, v1
    s_lshl_b32 s39, s58, 7
    v_add_u32 v10, s39, v9
    v_lshlrev_b32 v10, 1, v10
    v_lshlrev_b32 v11, 3, v0
    v_lshlrev_b32 v12, 1, v4
    v_xor_b32 v12, v5, v12
    v_lshlrev_b32 v12, 4, v12
    v_lshl_add_u32 v12, v4, 13, v12
    v_xor_b32 v13, 0x80, v12
    v_lshrrev_b32 v14, 3, v1
    v_and_b32 v15, 6, v14
    v_and_b32 v6, 7, v1
    v_xor_b32 v15, v6, v15
    v_lshlrev_b32 v15, 4, v15
    v_mul_u32_u24 v14, 6144, v14
    v_add_u32 v38, v14, v15
    s_lshl_b32 s60, s34, 3
    s_add_u32 s60, s60, s56
    s_and_b32 s61, s60, 1
    s_lshl_b32 s61, s61, 8
    s_lshr_b32 s62, s60, 1
    s_lshl_b32 s62, s62, 7
    s_waitcnt lgkmcnt(0)
    s_mov_b32 s40, s30
    s_mov_b32 s41, s31
    s_mov_b32 s42, 4210688
    s_mov_b32 s43, 0x20000
    s_load_dword s32, s[30:31], 0
    s_mov_b32 s48, s24
    s_mov_b32 s49, s25
    s_mov_b32 s50, 3145728
    s_mov_b32 s51, 0x20000
    s_cmp_eq_u32 s63, 0
    s_cbranch_scc1 L_noAdma
    s_mul_i32 s37, s33, 32
    s_add_u32 s37, s37, s61
    s_mul_i32 s37, s37, 6144
    s_add_u32 s37, s37, s62
    s_mul_i32 s38, s33, 4096
    s_add_u32 s38, s38, 32768
    s_add_u32 m0, s38, 0
    s_nop 0
    buffer_load_dwordx4 v38, s[48:51], s37 offen nt lds
    s_add_u32 s37, s37, 49152
    s_add_u32 m0, s38, 1024
    s_nop 0
    buffer_load_dwordx4 v38, s[48:51], s37 offen nt lds
    s_add_u32 s37, s37, 49152
    s_add_u32 m0, s38, 2048
    s_nop 0
    buffer_load_dwordx4 v38, s[48:51], s37 offen nt lds
    s_add_u32 s37, s37, 49152
    s_add_u32 m0, s38, 3072
    s_nop 0
    buffer_load_dwordx4 v38, s[48:51], s37 offen nt lds
L_noAdma:
    s_mov_b32 s44, s4
    s_mov_b32 s45, s5
    s_mov_b32 s46, 4096
    s_mov_b32 s47, 0x20000
    s_mov_b32 s52, s22
    s_mov_b32 s53, s23
    s_mov_b32 s54, 4096
    s_mov_b32 s55, 0x20000
    buffer_load_dwordx4 v[16:19], v8, s[44:47], s59 offen
    buffer_load_ushort v28, v10, s[44:47], s59 offen
    buffer_load_dwordx2 v[30:31], v11, s[52:55], 0 offen
    s_mov_b32 s52, s10
    s_mov_b32 s53, s11
    s_mov_b32 s54, 4194304
    s_mov_b32 s55, 0x20000
    s_cmp_eq_u32 s63, 0
    s_cbranch_scc1 L_gate
    s_barrier
    s_branch L_gated
L_gate:
L_gated:
    s_lshl_b32 s37, s58, 7
    s_lshl_b32 s38, s33, 4
    s_add_u32 s37, s37, s38
    s_lshl_b32 s37, s37, 13
    s_lshl_b32 s38, s57, 8
    s_add_u32 s37, s37, s38
    s_lshl_b32 s38, s33, 12
    s_add_u32 m0, s38, 0
    s_nop 0
    buffer_load_dwordx4 v12, s[52:55], s37 offen nt lds
    s_add_u32 s37, s37, 32768
    s_add_u32 m0, s38, 1024
    s_nop 0
    buffer_load_dwordx4 v13, s[52:55], s37 offen nt lds
    s_add_u32 s37, s37, 32768
    s_add_u32 m0, s38, 2048
    s_nop 0
    buffer_load_dwordx4 v12, s[52:55], s37 offen nt lds
    s_add_u32 s37, s37, 32768
    s_add_u32 m0, s38, 3072
    s_nop 0
    buffer_load_dwordx4 v13, s[52:55], s37 offen nt lds
    v_lshrrev_b32 v8, 2, v5
    v_and_b32 v9, 3, v5
    v_lshl_add_u32 v10, v4, 2, v8
    v_lshrrev_b32 v11, 1, v10
    v_and_b32 v11, 3, v11
    v_lshlrev_b32 v11, 5, v11
    v_lshl_add_u32 v11, v10, 7, v11
    v_lshl_add_u32 v36, v9, 3, v11
    s_and_b32 s37, s33, 3
    s_lshl_b32 s37, s37, 5
    v_xor_b32 v36, s37, v36
    v_and_b32 v11, 7, v10
    v_xor_b32 v11, s33, v11
    v_lshlrev_b32 v11, 5, v11
    v_lshl_add_u32 v11, v10, 8, v11
    v_lshl_add_u32 v37, v9, 3, v11
    v_mul_u32_u24 v34, 1088, v8
    v_lshl_add_u32 v34, v4, 4, v34
    v_mul_u32_u24 v6, 320, v8
    v_lshl_add_u32 v6, v4, 4, v6
    v_add_u32 v6, 102656, v6
    v_lshlrev_b32 v7, 10, v4
    v_lshl_add_u32 v7, v5, 3, v7
    v_lshlrev_b32 v39, 7, v5
    s_lshl_b32 s68, s34, 12
    s_add_u32 s68, s68, 3145728
    s_and_b32 s38, s33, 1
    s_lshl_b32 s38, s38, 6
    v_add_u32 v12, s38, v1
    v_and_b32 v13, 0xffffffe3, v12
    v_and_b32 v14, 12, v12
    v_lshlrev_b32 v14, 1, v14
    v_or_b32 v13, v13, v14
    v_and_b32 v14, 16, v12
    v_lshrrev_b32 v14, 2, v14
    v_or_b32 v13, v13, v14
    s_lshr_b32 s37, s33, 1
    s_mul_i32 s37, s37, 320
    s_add_u32 s37, s37, 102656
    v_lshl_add_u32 v33, v13, 1, s37
    v_and_b32 v12, 127, v0
    v_lshlrev_b32 v12, 2, v12
    v_and_b32 v13, 0xffffffe3, v12
    v_and_b32 v14, 12, v12
    v_lshlrev_b32 v14, 1, v14
    v_or_b32 v13, v13, v14
    v_and_b32 v14, 16, v12
    v_lshrrev_b32 v14, 2, v14
    v_or_b32 v13, v13, v14
    v_lshrrev_b32 v14, 7, v0
    v_mul_u32_u24 v14, 1088, v14
    v_lshl_add_u32 v13, v13, 1, v14
    v_add_u32 v13, 98304, v13
    s_lshl_b32 s37, s58, 1
    s_and_b32 s38, s33, 1
    s_add_u32 s37, s37, s38
    s_lshl_b32 s37, s37, 3
    s_lshr_b32 s38, s33, 1
    s_add_u32 s37, s37, s38
    s_lshl_b32 s37, s37, 9
    s_add_u32 s64, s37, 4096
    s_add_u32 s65, s64, 2048
    s_add_u32 s66, s64, 32768
    s_add_u32 s67, s66, 2048
    s_lshl_b32 s37, s57, 2
    s_add_u32 s37, s37, s58
    s_lshl_b32 s37, s37, 12
    s_lshl_b32 s38, s33, 7
    s_add_u32 s37, s37, s38
    s_add_u32 s69, s37, 102400
    s_waitcnt vmcnt(4)
    v_and_b32 v129, 0xffff0000, v30
    v_lshlrev_b32 v128, 16, v30
    v_and_b32 v131, 0xffff0000, v31
    v_lshlrev_b32 v130, 16, v31
    s_mov_b32 s38, 0xbfb8aa3b
    v_mul_f32 v132, s38, v128
    v_mul_f32 v133, s38, v129
    v_mul_f32 v134, s38, v130
    v_mul_f32 v135, s38, v131
    v_exp_f32 v132, v132
    v_exp_f32 v133, v133
    v_exp_f32 v134, v134
    v_exp_f32 v135, v135
    v_add_f32 v132, 1.0, v132
    v_add_f32 v133, 1.0, v133
    v_add_f32 v134, 1.0, v134
    v_add_f32 v135, 1.0, v135
    v_rcp_f32 v132, v132
    v_rcp_f32 v133, v133
    v_rcp_f32 v134, v134
    v_rcp_f32 v135, v135
    v_mul_f32 v128, v128, v132
    v_mul_f32 v129, v129, v133
    v_mul_f32 v130, v130, v134
    v_mul_f32 v131, v131, v135
    v_cvt_pk_bf16_f32 v128, v128, v129
    v_cvt_pk_bf16_f32 v129, v130, v131
    ds_write_b64 v13, v[128:129]
    s_waitcnt lgkmcnt(0)
    s_add_u32 s32, s32, 0x9e3779b9
    s_cmp_eq_u32 s33, 0
    s_cbranch_scc0 L_xt_24
    s_lshl_b32 s37, s34, 5
    s_add_u32 s37, s37, s35
    s_lshl_b32 s37, s37, 7
    s_add_u32 s37, s37, 3145728
    v_mov_b32 v138, s70
    v_mov_b32 v139, s32
    v_mov_b32 v140, 0
    s_mov_b64 exec, 1
    buffer_store_dwordx2 v[138:139], v140, s[40:43], s37 offen sc1
    s_mov_b64 exec, -1
L_xt_24:
    s_cmp_eq_u32 s63, 0
    s_cbranch_scc1 L_noA
    s_barrier
    s_cmp_lt_u32 s33, 4
    s_cbranch_scc0 L_noA
    s_lshl_b32 s37, s61, 1
    s_add_u32 s37, s37, 98304
    v_add_u32 v8, s37, v34
    ds_read_b128 v[72:75], v8 offset:0
    ds_read_b64_tr_b16 v[40:41], v36 offset:32768
    ds_read_b64_tr_b16 v[42:43], v36 offset:34816
    ds_read_b128 v[76:79], v8 offset:64
    ds_read_b64_tr_b16 v[44:45], v36 offset:36864
    ds_read_b64_tr_b16 v[46:47], v36 offset:38912
    ds_read_b128 v[80:83], v8 offset:128
    ds_read_b64_tr_b16 v[48:49], v36 offset:40960
    ds_read_b64_tr_b16 v[50:51], v36 offset:43008
    ds_read_b128 v[84:87], v8 offset:192
    ds_read_b64_tr_b16 v[52:53], v36 offset:45056
    ds_read_b64_tr_b16 v[54:55], v36 offset:47104
    s_waitcnt lgkmcnt(9)
    v_mfma_f32_16x16x32_bf16 v[124:127], v[72:75], v[40:43], 0
    ds_read_b128 v[88:91], v8 offset:256
    ds_read_b64_tr_b16 v[56:57], v36 offset:49152
    ds_read_b64_tr_b16 v[58:59], v36 offset:51200
    s_waitcnt lgkmcnt(9)
    v_mfma_f32_16x16x32_bf16 v[124:127], v[76:79], v[44:47], v[124:127]
    ds_read_b128 v[92:95], v8 offset:320
    ds_read_b64_tr_b16 v[60:61], v36 offset:53248
    ds_read_b64_tr_b16 v[62:63], v36 offset:55296
    s_waitcnt lgkmcnt(9)
    v_mfma_f32_16x16x32_bf16 v[124:127], v[80:83], v[48:51], v[124:127]
    ds_read_b128 v[96:99], v8 offset:384
    ds_read_b64_tr_b16 v[64:65], v36 offset:57344
    ds_read_b64_tr_b16 v[66:67], v36 offset:59392
    s_waitcnt lgkmcnt(9)
    v_mfma_f32_16x16x32_bf16 v[124:127], v[84:87], v[52:55], v[124:127]
    ds_read_b128 v[100:103], v8 offset:448
    ds_read_b64_tr_b16 v[68:69], v36 offset:61440
    ds_read_b64_tr_b16 v[70:71], v36 offset:63488
    s_waitcnt lgkmcnt(9)
    v_mfma_f32_16x16x32_bf16 v[124:127], v[88:91], v[56:59], v[124:127]
    s_lshl_b32 s37, s60, 11
    s_lshl_b32 s38, s33, 7
    s_add_u32 s37, s37, s38
    s_add_u32 s37, s37, 4096
    v_lshlrev_b32 v8, 9, v4
    v_lshl_add_u32 v8, v5, 3, v8
    v_mov_b32 v129, s32
    s_waitcnt lgkmcnt(6)
    v_mfma_f32_16x16x32_bf16 v[124:127], v[92:95], v[60:63], v[124:127]
    s_waitcnt lgkmcnt(3)
    v_mfma_f32_16x16x32_bf16 v[124:127], v[96:99], v[64:67], v[124:127]
    s_waitcnt lgkmcnt(0)
    v_mfma_f32_16x16x32_bf16 v[124:127], v[100:103], v[68:71], v[124:127]
    s_nop 7
    v_mov_b32 v128, v124
    buffer_store_dwordx2 v[128:129], v8, s[40:43], s37 offen sc1
L_noA:
    v_and_b32 v21, 0xffff0000, v16
    v_lshlrev_b32 v20, 16, v16
    v_and_b32 v23, 0xffff0000, v17
    v_lshlrev_b32 v22, 16, v17
    v_and_b32 v25, 0xffff0000, v18
    v_lshlrev_b32 v24, 16, v18
    v_and_b32 v27, 0xffff0000, v19
    v_lshlrev_b32 v26, 16, v19
    v_add_f32 v8, v20, v21
    v_mul_f32 v9, v20, v20
    v_fmac_f32 v9, v21, v21
    v_add_f32 v8, v8, v22
    v_fmac_f32 v9, v22, v22
    v_add_f32 v8, v8, v23
    v_fmac_f32 v9, v23, v23
    v_add_f32 v8, v8, v24
    v_fmac_f32 v9, v24, v24
    v_add_f32 v8, v8, v25
    v_fmac_f32 v9, v25, v25
    v_add_f32 v8, v8, v26
    v_fmac_f32 v9, v26, v26
    v_add_f32 v8, v8, v27
    v_fmac_f32 v9, v27, v27
    s_nop 0
    v_add_f32_dpp v8, v8, v8 quad_perm:[1,0,3,2] row_mask:0xf bank_mask:0xf
    v_add_f32_dpp v9, v9, v9 quad_perm:[1,0,3,2] row_mask:0xf bank_mask:0xf
    s_nop 0
    v_add_f32_dpp v8, v8, v8 quad_perm:[2,3,0,1] row_mask:0xf bank_mask:0xf
    v_add_f32_dpp v9, v9, v9 quad_perm:[2,3,0,1] row_mask:0xf bank_mask:0xf
    s_nop 0
    v_add_f32_dpp v8, v8, v8 row_half_mirror row_mask:0xf bank_mask:0xf
    v_add_f32_dpp v9, v9, v9 row_half_mirror row_mask:0xf bank_mask:0xf
    s_nop 0
    v_add_f32_dpp v8, v8, v8 row_mirror row_mask:0xf bank_mask:0xf
    v_add_f32_dpp v9, v9, v9 row_mirror row_mask:0xf bank_mask:0xf
    v_mov_b32 v10, v8
    v_mov_b32 v11, v9
    s_nop 0
    v_permlane16_swap_b32 v8, v10
    v_permlane16_swap_b32 v9, v11
    v_add_f32 v8, v8, v10
    v_add_f32 v9, v9, v11
    v_mov_b32 v10, v8
    v_mov_b32 v11, v9
    s_nop 0
    v_permlane32_swap_b32 v8, v10
    v_permlane32_swap_b32 v9, v11
    v_add_f32 v8, v8, v10
    v_add_f32 v9, v9, v11
    v_mul_f32 v8, 0x3b000000, v8
    v_mul_f32 v9, 0x3b000000, v9
    v_fma_f32 v9, -v8, v8, v9
    v_max_f32 v9, 0, v9
    v_cvt_pk_bf16_f32 v9, v9, v8
    v_and_b32 v12, 0xffff0000, v9
    v_lshlrev_b32 v9, 16, v9
    v_add_f32 v9, 0x3727c5ac, v9
    v_cvt_pk_bf16_f32 v9, v9, v9
    v_lshlrev_b32 v9, 16, v9
    v_sqrt_f32 v9, v9
    s_nop 0
    v_cvt_pk_bf16_f32 v9, v9, v9
    v_lshlrev_b32 v9, 16, v9
    v_rcp_f32 v13, v9
    v_lshlrev_b32 v32, 16, v28
    v_sub_f32 v32, v32, v12
    v_cvt_pk_bf16_f32 v32, v32, v32
    v_lshlrev_b32 v32, 16, v32
    v_mul_f32 v32, v32, v13
    v_cvt_pk_bf16_f32 v32, v32, v32
    v_lshlrev_b32 v32, 16, v32
    s_cmp_lt_u32 s33, 4
    s_cselect_b32 s37, s63, 0
    s_cmp_eq_u32 s33, 0
    s_addc_u32 s37, s37, 0
    s_cmp_eq_u32 s37, 0
    s_cbranch_scc1 L_wq0
    s_cmp_eq_u32 s37, 1
    s_cbranch_scc1 L_wq2
    s_waitcnt vmcnt(2) lgkmcnt(0)
    s_branch L_wq1
L_wq2:
    s_waitcnt vmcnt(1) lgkmcnt(0)
    s_branch L_wq1
L_wq0:
    s_waitcnt vmcnt(0) lgkmcnt(0)
L_wq1:
    s_barrier
    ds_read_b64_tr_b16 v[40:41], v37 offset:0
    ds_read_b64_tr_b16 v[42:43], v37 offset:4096
    ds_read_b64_tr_b16 v[44:45], v37 offset:8192
    ds_read_b64_tr_b16 v[46:47], v37 offset:12288
    ds_read_b64_tr_b16 v[48:49], v37 offset:16384
    ds_read_b64_tr_b16 v[50:51], v37 offset:20480
    ds_read_b64_tr_b16 v[52:53], v37 offset:24576
    ds_read_b64_tr_b16 v[54:55], v37 offset:28672
L_poll_25:
    buffer_load_dwordx2 v[128:129], v35, s[40:43], s64 offen sc1
    buffer_load_dwordx2 v[130:131], v35, s[40:43], s65 offen sc1
    buffer_load_dwordx2 v[132:133], v35, s[40:43], s66 offen sc1
    buffer_load_dwordx2 v[134:135], v35, s[40:43], s67 offen sc1
    buffer_load_dwordx2 v[136:137], v39, s[40:43], s68 offen sc1
    s_add_u32 s36, s36, 1
    s_cmp_gt_u32 s36, 400000
    s_cbranch_scc1 L_pollx_26
    s_waitcnt vmcnt(0)
    v_cmpx_eq_u32 vcc, s32, v129
    v_cmpx_eq_u32 vcc, s32, v131
    v_cmpx_eq_u32 vcc, s32, v133
    v_cmpx_eq_u32 vcc, s32, v135
    s_cmp_eq_u64 exec, -1
    s_mov_b64 exec, -1
    s_cbranch_scc0 L_poll_25
    s_branch L_pollx_26_ok
L_pollx_26:
    s_waitcnt vmcnt(0)
L_pollx_26_ok:
    v_add_f32 v128, v128, v130
    v_add_f32 v132, v132, v134
    v_cvt_pk_bf16_f32 v129, v128, v132
    v_and_b32 v132, 0xffff0000, v129
    v_lshlrev_b32 v128, 16, v129
    v_add_f32 v132, 1.0, v132
    v_cvt_pk_bf16_f32 v132, v132, v132
    v_lshlrev_b32 v132, 16, v132
    v_mul_f32 v132, v32, v132
    v_cvt_pk_bf16_f32 v132, v132, v132
    v_lshlrev_b32 v132, 16, v132
    v_add_f32 v128, v128, v132
    v_cvt_pk_bf16_f32 v128, v128, v128
    ds_write_b16 v33, v128
    v_cmp_eq_u32 vcc, s70, v136
    v_cmp_eq_u32 s[38:39], s32, v137
    s_and_b64 vcc, vcc, s[38:39]
    s_cmp_eq_u64 vcc, -1
    s_cselect_b32 s71, 1, 0
    s_waitcnt lgkmcnt(0)
    s_barrier
    ds_read_b128 v[72:75], v6 offset:0
    ds_read_b128 v[76:79], v6 offset:64
    ds_read_b128 v[80:83], v6 offset:128
    ds_read_b128 v[84:87], v6 offset:192
    v_mov_b32 v129, s32
    s_waitcnt lgkmcnt(3)
    v_mfma_f32_16x16x32_bf16 v[124:127], v[72:75], v[40:43], 0
    s_waitcnt lgkmcnt(2)
    v_mfma_f32_16x16x32_bf16 v[124:127], v[76:79], v[44:47], v[124:127]
    s_waitcnt lgkmcnt(1)
    v_mfma_f32_16x16x32_bf16 v[124:127], v[80:83], v[48:51], v[124:127]
    s_waitcnt lgkmcnt(0)
    v_mfma_f32_16x16x32_bf16 v[124:127], v[84:87], v[52:55], v[124:127]
    s_nop 7
    v_mov_b32 v128, v124
    s_cmp_eq_u32 s71, 0
    s_cbranch_scc1 L_rem_27
    buffer_store_dwordx2 v[128:129], v7, s[40:43], s69 offen
    s_branch L_pubx_28
L_rem_27:
    buffer_store_dwordx2 v[128:129], v7, s[40:43], s69 offen sc1
L_pubx_28:
    s_cmp_lt_u32 s56, 8
    s_cbranch_scc0 L_hi
    s_cmp_lt_u32 s56, 4
    s_cbranch_scc0 L_na_done
    s_lshl_b32 s60, s34, 2
    s_add_u32 s60, s60, s56
    s_lshl_b32 s62, s60, 7
    s_add_u32 s62, s62, 2048
    s_mov_b32 s61, 0
    s_mul_i32 s37, s33, 64
    s_add_u32 s37, s37, s61
    s_mul_i32 s37, s37, 6144
    s_add_u32 s37, s37, s62
    s_mul_i32 s38, s33, 8192
    s_add_u32 s38, s38, 32768
    s_add_u32 m0, s38, 0
    s_nop 0
    buffer_load_dwordx4 v38, s[48:51], s37 offen nt lds
    s_add_u32 s37, s37, 49152
    s_add_u32 m0, s38, 1024
    s_nop 0
    buffer_load_dwordx4 v38, s[48:51], s37 offen nt lds
    s_add_u32 s37, s37, 49152
    s_add_u32 m0, s38, 2048
    s_nop 0
    buffer_load_dwordx4 v38, s[48:51], s37 offen nt lds
    s_add_u32 s37, s37, 49152
    s_add_u32 m0, s38, 3072
    s_nop 0
    buffer_load_dwordx4 v38, s[48:51], s37 offen nt lds
    s_add_u32 s37, s37, 49152
    s_add_u32 m0, s38, 4096
    s_nop 0
    buffer_load_dwordx4 v38, s[48:51], s37 offen nt lds
    s_add_u32 s37, s37, 49152
    s_add_u32 m0, s38, 5120
    s_nop 0
    buffer_load_dwordx4 v38, s[48:51], s37 offen nt lds
    s_add_u32 s37, s37, 49152
    s_add_u32 m0, s38, 6144
    s_nop 0
    buffer_load_dwordx4 v38, s[48:51], s37 offen nt lds
    s_add_u32 s37, s37, 49152
    s_add_u32 m0, s38, 7168
    s_nop 0
    buffer_load_dwordx4 v38, s[48:51], s37 offen nt lds
    s_waitcnt vmcnt(0)
    s_barrier
    s_cmp_lt_u32 s33, 4
    s_cbranch_scc0 L_na_done
    v_add_u32 v8, 98304, v34
    ds_read_b128 v[72:75], v8 offset:0
    ds_read_b128 v[76:79], v8 offset:64
    ds_read_b128 v[80:83], v8 offset:128
    ds_read_b128 v[84:87], v8 offset:192
    ds_read_b128 v[88:91], v8 offset:256
    ds_read_b128 v[92:95], v8 offset:320
    ds_read_b128 v[96:99], v8 offset:384
    ds_read_b128 v[100:103], v8 offset:448
    s_waitcnt lgkmcnt(0)
    ds_read_b64_tr_b16 v[40:41], v36 offset:32768
    ds_read_b64_tr_b16 v[42:43], v36 offset:34816
    ds_read_b64_tr_b16 v[44:45], v36 offset:36864
    ds_read_b64_tr_b16 v[46:47], v36 offset:38912
    ds_read_b64_tr_b16 v[48:49], v36 offset:40960
    ds_read_b64_tr_b16 v[50:51], v36 offset:43008
    ds_read_b64_tr_b16 v[52:53], v36 offset:45056
    ds_read_b64_tr_b16 v[54:55], v36 offset:47104
    ds_read_b64_tr_b16 v[56:57], v36 offset:49152
    ds_read_b64_tr_b16 v[58:59], v36 offset:51200
    ds_read_b64_tr_b16 v[60:61], v36 offset:53248
    ds_read_b64_tr_b16 v[62:63], v36 offset:55296
    ds_read_b64_tr_b16 v[64:65], v36 offset:57344
    ds_read_b64_tr_b16 v[66:67], v36 offset:59392
    ds_read_b64_tr_b16 v[68:69], v36 offset:61440
    ds_read_b64_tr_b16 v[70:71], v36 offset:63488
    s_waitcnt lgkmcnt(0)
    v_mfma_f32_16x16x32_bf16 v[124:127], v[72:75], v[40:43], 0
    v_mfma_f32_16x16x32_bf16 v[124:127], v[76:79], v[44:47], v[124:127]
    v_mfma_f32_16x16x32_bf16 v[124:127], v[80:83], v[48:51], v[124:127]
    v_mfma_f32_16x16x32_bf16 v[124:127], v[84:87], v[52:55], v[124:127]
    v_mfma_f32_16x16x32_bf16 v[124:127], v[88:91], v[56:59], v[124:127]
    v_mfma_f32_16x16x32_bf16 v[124:127], v[92:95], v[60:63], v[124:127]
    v_mfma_f32_16x16x32_bf16 v[124:127], v[96:99], v[64:67], v[124:127]
    v_mfma_f32_16x16x32_bf16 v[124:127], v[100:103], v[68:71], v[124:127]
    v_add_u32 v9, 65536, v36
    ds_read_b128 v[72:75], v8 offset:512
    ds_read_b128 v[76:79], v8 offset:576
    ds_read_b128 v[80:83], v8 offset:640
    ds_read_b128 v[84:87], v8 offset:704
    ds_read_b128 v[88:91], v8 offset:768
    ds_read_b128 v[92:95], v8 offset:832
    ds_read_b128 v[96:99], v8 offset:896
    ds_read_b128 v[100:103], v8 offset:960
    s_waitcnt lgkmcnt(0)
    ds_read_b64_tr_b16 v[40:41], v9 offset:0
    ds_read_b64_tr_b16 v[42:43], v9 offset:2048
    ds_read_b64_tr_b16 v[44:45], v9 offset:4096
    ds_read_b64_tr_b16 v[46:47], v9 offset:6144
    ds_read_b64_tr_b16 v[48:49], v9 offset:8192
    ds_read_b64_tr_b16 v[50:51], v9 offset:10240
    ds_read_b64_tr_b16 v[52:53], v9 offset:12288
    ds_read_b64_tr_b16 v[54:55], v9 offset:14336
    ds_read_b64_tr_b16 v[56:57], v9 offset:16384
    ds_read_b64_tr_b16 v[58:59], v9 offset:18432
    ds_read_b64_tr_b16 v[60:61], v9 offset:20480
    ds_read_b64_tr_b16 v[62:63], v9 offset:22528
    ds_read_b64_tr_b16 v[64:65], v9 offset:24576
    ds_read_b64_tr_b16 v[66:67], v9 offset:26624
    ds_read_b64_tr_b16 v[68:69], v9 offset:28672
    ds_read_b64_tr_b16 v[70:71], v9 offset:30720
    s_waitcnt lgkmcnt(0)
    v_mfma_f32_16x16x32_bf16 v[124:127], v[72:75], v[40:43], v[124:127]
    v_mfma_f32_16x16x32_bf16 v[124:127], v[76:79], v[44:47], v[124:127]
    v_mfma_f32_16x16x32_bf16 v[124:127], v[80:83], v[48:51], v[124:127]
    v_mfma_f32_16x16x32_bf16 v[124:127], v[84:87], v[52:55], v[124:127]
    v_mfma_f32_16x16x32_bf16 v[124:127], v[88:91], v[56:59], v[124:127]
    v_mfma_f32_16x16x32_bf16 v[124:127], v[92:95], v[60:63], v[124:127]
    v_mfma_f32_16x16x32_bf16 v[124:127], v[96:99], v[64:67], v[124:127]
    v_mfma_f32_16x16x32_bf16 v[124:127], v[100:103], v[68:71], v[124:127]
    s_lshr_b32 s37, s60, 3
    s_lshl_b32 s37, s37, 13
    s_and_b32 s38, s60, 7
    s_lshl_b32 s38, s38, 8
    s_add_u32 s37, s37, s38
    s_lshl_b32 s38, s33, 6
    s_add_u32 s37, s37, s38
    s_add_u32 s37, s37, 69632
    v_lshlrev_b32 v8, 11, v4
    v_lshl_add_u32 v8, v5, 2, v8
    v_mov_b32 v129, s32
    v_mov_b32_dpp v130, v124 quad_perm:[1,0,3,2] row_mask:0xf bank_mask:0xf
    v_cvt_pk_bf16_f32 v128, v124, v130
    s_mov_b32 exec_lo, 0x55555555
    s_mov_b32 exec_hi, 0x55555555
    buffer_store_dwordx2 v[128:129], v8, s[40:43], s37 offen sc1
    s_mov_b64 exec, -1
    s_branch L_na_done
L_hi:
    s_cmp_eq_u32 s56, 15
    s_cbranch_scc1 L_na_done
    s_mul_i32 s60, s34, 7
    s_add_u32 s60, s60, s56
    s_sub_u32 s60, s60, 8
    s_mov_b32 s44, s16
    s_mov_b32 s45, s17
    s_mov_b32 s46, 1835008
    s_mov_b32 s47, 0x20000
    s_mov_b32 s48, s18
    s_mov_b32 s49, s19
    s_mov_b32 s50, 1835008
    s_mov_b32 s51, 0x20000
    s_mov_b32 s52, s20
    s_mov_b32 s53, s21
    s_mov_b32 s54, 1835008
    s_mov_b32 s55, 0x20000
    v_lshrrev_b32 v8, 2, v1
    v_lshrrev_b32 v9, 1, v8
    v_and_b32 v9, 2, v9
    v_and_b32 v10, 3, v1
    v_xor_b32 v9, v10, v9
    v_lshlrev_b32 v9, 4, v9
    v_mul_u32_u24 v8, 3584, v8
    v_add_u32 v8, v8, v9
    s_lshl_b32 s37, s33, 6
    s_mul_i32 s37, s37, 3584
    s_lshl_b32 s38, s60, 6
    s_add_u32 s37, s37, s38
    s_lshl_b32 s38, s33, 12
    s_add_u32 m0, s38, 0
    s_nop 0
    buffer_load_dwordx4 v8, s[44:47], s37 offen lds
    s_add_u32 m0, s38, 32768
    s_nop 0
    buffer_load_dwordx4 v8, s[48:51], s37 offen lds
    s_add_u32 s37, s37, 57344
    s_add_u32 m0, s38, 1024
    s_nop 0
    buffer_load_dwordx4 v8, s[44:47], s37 offen lds
    s_add_u32 m0, s38, 33792
    s_nop 0
    buffer_load_dwordx4 v8, s[48:51], s37 offen lds
    s_add_u32 s37, s37, 57344
    s_add_u32 m0, s38, 2048
    s_nop 0
    buffer_load_dwordx4 v8, s[44:47], s37 offen lds
    s_add_u32 m0, s38, 34816
    s_nop 0
    buffer_load_dwordx4 v8, s[48:51], s37 offen lds
    s_add_u32 s37, s37, 57344
    s_add_u32 m0, s38, 3072
    s_nop 0
    buffer_load_dwordx4 v8, s[44:47], s37 offen lds
    s_add_u32 m0, s38, 35840
    s_nop 0
    buffer_load_dwordx4 v8, s[48:51], s37 offen lds
    v_lshlrev_b32 v9, 4, v1
    s_lshl_b32 s37, s60, 5
    s_lshl_b32 s38, s33, 2
    s_add_u32 s37, s37, s38
    s_lshl_b32 s37, s37, 10
    s_lshl_b32 s38, s33, 12
    s_and_b32 s39, s33, 1
    s_lshl_b32 s39, s39, 7
    v_xor_b32 v9, s39, v9
    s_add_u32 m0, s38, 65536
    s_nop 0
    buffer_load_dwordx4 v9, s[52:55], s37 offen offset:0 nt lds
    v_xor_b32 v10, 32, v9
    buffer_load_dwordx4 v10, s[52:55], s37 offen offset:1024 nt lds
    v_xor_b32 v10, 64, v9
    buffer_load_dwordx4 v10, s[52:55], s37 offen offset:2048 nt lds
    v_xor_b32 v10, 96, v9
    buffer_load_dwordx4 v10, s[52:55], s37 offen offset:3072 nt lds
    v_lshrrev_b32 v8, 2, v5
    v_and_b32 v9, 3, v5
    v_lshl_add_u32 v10, v4, 2, v8
    v_and_b32 v12, 1, v4
    s_and_b32 s37, s33, 1
    v_xor_b32 v12, s37, v12
    v_lshlrev_b32 v12, 5, v12
    v_lshl_add_u32 v12, v10, 6, v12
    v_lshl_add_u32 v12, v9, 3, v12
    s_lshr_b32 s37, s33, 1
    s_and_b32 s37, s37, 1
    s_lshl_b32 s37, s37, 15
    s_lshr_b32 s38, s33, 2
    s_lshl_b32 s38, s38, 14
    s_add_u32 s37, s37, s38
    v_add_u32 v24, s37, v12
    v_and_b32 v13, 7, v10
    s_and_b32 s37, s33, 1
    s_lshl_b32 s37, s37, 2
    v_xor_b32 v13, s37, v13
    v_lshlrev_b32 v13, 5, v13
    v_lshl_add_u32 v13, v10, 10, v13
    v_lshl_add_u32 v13, v9, 3, v13
    s_lshr_b32 s37, s33, 1
    s_lshl_b32 s37, s37, 8
    s_add_u32 s37, s37, 65536
    v_add_u32 v25, s37, v13
    s_and_b32 s37, s33, 3
    s_mul_i32 s37, s37, 1088
    s_lshr_b32 s38, s33, 2
    s_lshl_b32 s38, s38, 3
    s_add_u32 s37, s37, s38
    s_add_u32 s37, s37, 103936
    v_lshl_add_u32 v16, v1, 4, s37
    v_lshrrev_b32 v8, 2, v1
    v_lshlrev_b32 v8, 7, v8
    v_and_b32 v9, 3, v1
    v_lshl_add_u32 v8, v9, 4, v8
    s_lshl_b32 s38, s38, 3
    v_add_u32 v27, s38, v8
    s_lshr_b32 s37, s33, 2
    s_lshl_b32 s37, s37, 9
    s_add_u32 s37, s37, 103936
    v_add_u32 v18, s37, v34
    s_lshr_b32 s37, s33, 1
    s_lshl_b32 s37, s37, 9
    s_and_b32 s38, s33, 1
    s_lshl_b32 s38, s38, 6
    s_add_u32 s37, s37, s38
    s_add_u32 s37, s37, 108288
    v_lshlrev_b32 v19, 7, v4
    v_lshl_add_u32 v19, v5, 2, v19
    v_add_u32 v19, s37, v19
    v_lshlrev_b32 v20, 2, v0
    v_add_u32 v20, 108288, v20
    v_and_b32 v8, 31, v0
    v_and_b32 v9, 0xffffffe3, v8
    v_and_b32 v10, 12, v8
    v_lshlrev_b32 v10, 1, v10
    v_or_b32 v9, v9, v10
    v_and_b32 v10, 16, v8
    v_lshrrev_b32 v10, 2, v10
    v_or_b32 v9, v9, v10
    v_lshrrev_b32 v8, 5, v0
    v_lshlrev_b32 v8, 6, v8
    v_lshl_add_u32 v21, v9, 1, v8
    v_add_u32 v21, 110336, v21
    v_lshrrev_b32 v8, 2, v5
    v_lshlrev_b32 v8, 6, v8
    v_lshl_add_u32 v22, v4, 4, v8
    v_add_u32 v22, 110336, v22
    v_lshrrev_b32 v8, 2, v5
    v_lshl_add_u32 v8, v4, 5, v8
    v_mul_u32_u24 v23, 3584, v8
    v_and_b32 v8, 3, v5
    v_lshl_add_u32 v23, v8, 4, v23
    s_mul_i32 s67, s33, 14336
    s_lshl_b32 s37, s60, 6
    s_add_u32 s67, s67, s37
    s_add_u32 s67, s67, 2134016
    v_lshlrev_b32 v26, 5, v1
    s_and_b32 s37, s33, 3
    s_lshl_b32 s37, s37, 11
    s_add_u32 s64, s37, 77824
    s_add_u32 s65, s37, 86016
    s_lshl_b32 s66, s34, 13
    s_add_u32 s66, s66, s37
    s_add_u32 s66, s66, 2068480
    s_waitcnt vmcnt(0)
    s_barrier
    ds_read_b64_tr_b16 v[40:41], v24 offset:0
    ds_read_b64_tr_b16 v[42:43], v24 offset:1024
    ds_read_b64_tr_b16 v[44:45], v24 offset:2048
    ds_read_b64_tr_b16 v[46:47], v24 offset:3072
    ds_read_b64_tr_b16 v[48:49], v24 offset:4096
    ds_read_b64_tr_b16 v[50:51], v24 offset:5120
    ds_read_b64_tr_b16 v[52:53], v24 offset:6144
    ds_read_b64_tr_b16 v[54:55], v24 offset:7168
    ds_read_b64_tr_b16 v[56:57], v24 offset:8192
    ds_read_b64_tr_b16 v[58:59], v24 offset:9216
    ds_read_b64_tr_b16 v[60:61], v24 offset:10240
    ds_read_b64_tr_b16 v[62:63], v24 offset:11264
    ds_read_b64_tr_b16 v[64:65], v24 offset:12288
    ds_read_b64_tr_b16 v[66:67], v24 offset:13312
    ds_read_b64_tr_b16 v[68:69], v24 offset:14336
    ds_read_b64_tr_b16 v[70:71], v24 offset:15360
    s_waitcnt lgkmcnt(0)
    ds_read_b64_tr_b16 v[72:73], v25 offset:0
    ds_read_b64_tr_b16 v[74:75], v25 offset:16384
    v_xor_b32 v14, 32, v25
    ds_read_b64_tr_b16 v[76:77], v14 offset:0
    ds_read_b64_tr_b16 v[78:79], v14 offset:16384
    v_xor_b32 v14, 64, v25
    ds_read_b64_tr_b16 v[80:81], v14 offset:0
    ds_read_b64_tr_b16 v[82:83], v14 offset:16384
    v_xor_b32 v14, 96, v25
    ds_read_b64_tr_b16 v[84:85], v14 offset:0
    ds_read_b64_tr_b16 v[86:87], v14 offset:16384
L_poll_29:
    buffer_load_dwordx4 v[128:131], v27, s[40:43], s64 offen sc1
    buffer_load_dwordx4 v[132:135], v27, s[40:43], s65 offen sc1
    s_add_u32 s36, s36, 1
    s_cmp_gt_u32 s36, 400000
    s_cbranch_scc1 L_pollx_30
    s_waitcnt vmcnt(0)
    v_cmpx_eq_u32 vcc, s32, v129
    v_cmpx_eq_u32 vcc, s32, v131
    v_cmpx_eq_u32 vcc, s32, v133
    v_cmpx_eq_u32 vcc, s32, v135
    s_cmp_eq_u64 exec, -1
    s_mov_b64 exec, -1
    s_cbranch_scc0 L_poll_29
    s_branch L_pollx_30_ok
L_pollx_30:
    s_waitcnt vmcnt(0)
L_pollx_30_ok:
    v_and_b32 v145, 0xffff0000, v128
    v_lshlrev_b32 v144, 16, v128
    v_and_b32 v147, 0xffff0000, v130
    v_lshlrev_b32 v146, 16, v130
    v_and_b32 v149, 0xffff0000, v132
    v_lshlrev_b32 v148, 16, v132
    v_and_b32 v151, 0xffff0000, v134
    v_lshlrev_b32 v150, 16, v134
    v_add_f32 v148, 1.0, v148
    v_add_f32 v149, 1.0, v149
    v_add_f32 v150, 1.0, v150
    v_add_f32 v151, 1.0, v151
    v_cvt_pk_bf16_f32 v128, v148, v149
    v_and_b32 v149, 0xffff0000, v128
    v_lshlrev_b32 v148, 16, v128
    v_cvt_pk_bf16_f32 v129, v150, v151
    v_and_b32 v151, 0xffff0000, v129
    v_lshlrev_b32 v150, 16, v129
    s_waitcnt lgkmcnt(0)
L_poll_31:
    buffer_load_dwordx4 v[128:131], v26, s[40:43], s66 offen sc1
    buffer_load_dwordx4 v[132:135], v26, s[40:43], s66 offen offset:16 sc1
    s_add_u32 s36, s36, 1
    s_cmp_gt_u32 s36, 400000
    s_cbranch_scc1 L_pollx_32
    s_waitcnt vmcnt(0)
    v_cmpx_eq_u32 vcc, s32, v129
    v_cmpx_eq_u32 vcc, s32, v131
    v_cmpx_eq_u32 vcc, s32, v133
    v_cmpx_eq_u32 vcc, s32, v135
    s_cmp_eq_u64 exec, -1
    s_mov_b64 exec, -1
    s_cbranch_scc0 L_poll_31
    s_branch L_pollx_32_ok
L_pollx_32:
    s_waitcnt vmcnt(0)
L_pollx_32_ok:
    v_and_b32 v105, 0xffff0000, v128
    v_lshlrev_b32 v104, 16, v128
    v_and_b32 v107, 0xffff0000, v130
    v_lshlrev_b32 v106, 16, v130
    v_and_b32 v109, 0xffff0000, v132
    v_lshlrev_b32 v108, 16, v132
    v_and_b32 v111, 0xffff0000, v134
    v_lshlrev_b32 v110, 16, v134
    v_add_f32 v8, v104, v105
    v_mul_f32 v9, v104, v104
    v_fmac_f32 v9, v105, v105
    v_add_f32 v8, v8, v106
    v_fmac_f32 v9, v106, v106
    v_add_f32 v8, v8, v107
    v_fmac_f32 v9, v107, v107
    v_add_f32 v8, v8, v108
    v_fmac_f32 v9, v108, v108
    v_add_f32 v8, v8, v109
    v_fmac_f32 v9, v109, v109
    v_add_f32 v8, v8, v110
    v_fmac_f32 v9, v110, v110
    v_add_f32 v8, v8, v111
    v_fmac_f32 v9, v111, v111
    s_nop 0
    v_add_f32_dpp v8, v8, v8 quad_perm:[1,0,3,2] row_mask:0xf bank_mask:0xf
    v_add_f32_dpp v9, v9, v9 quad_perm:[1,0,3,2] row_mask:0xf bank_mask:0xf
    s_nop 0
    v_add_f32_dpp v8, v8, v8 quad_perm:[2,3,0,1] row_mask:0xf bank_mask:0xf
    v_add_f32_dpp v9, v9, v9 quad_perm:[2,3,0,1] row_mask:0xf bank_mask:0xf
    s_nop 0
    v_add_f32_dpp v8, v8, v8 row_half_mirror row_mask:0xf bank_mask:0xf
    v_add_f32_dpp v9, v9, v9 row_half_mirror row_mask:0xf bank_mask:0xf
    s_nop 0
    v_add_f32_dpp v8, v8, v8 row_mirror row_mask:0xf bank_mask:0xf
    v_add_f32_dpp v9, v9, v9 row_mirror row_mask:0xf bank_mask:0xf
    v_mov_b32 v10, v8
    v_mov_b32 v11, v9
    s_nop 0
    v_permlane16_swap_b32 v8, v10
    v_permlane16_swap_b32 v9, v11
    v_add_f32 v8, v8, v10
    v_add_f32 v9, v9, v11
    v_mov_b32 v10, v8
    v_mov_b32 v11, v9
    s_nop 0
    v_permlane32_swap_b32 v8, v10
    v_permlane32_swap_b32 v9, v11
    v_add_f32 v8, v8, v10
    v_add_f32 v9, v9, v11
    v_mul_f32 v8, 0x3b000000, v8
    v_mul_f32 v9, 0x3b000000, v9
    v_fma_f32 v9, -v8, v8, v9
    v_max_f32 v9, 0, v9
    v_cvt_pk_bf16_f32 v9, v9, v8
    v_and_b32 v12, 0xffff0000, v9
    v_lshlrev_b32 v9, 16, v9
    v_add_f32 v9, 0x3727c5ac, v9
    v_cvt_pk_bf16_f32 v9, v9, v9
    v_lshlrev_b32 v9, 16, v9
    v_sqrt_f32 v9, v9
    s_nop 0
    v_cvt_pk_bf16_f32 v9, v9, v9
    v_lshlrev_b32 v9, 16, v9
    v_rcp_f32 v13, v9
    s_cmp_lt_u32 s33, 4
    s_cbranch_scc1 L_F_lo
    v_mov_b32 v104, v108
    v_mov_b32 v105, v109
    v_mov_b32 v106, v110
    v_mov_b32 v107, v111
L_F_lo:
    v_sub_f32 v104, v104, v12
    v_sub_f32 v105, v105, v12
    v_sub_f32 v106, v106, v12
    v_sub_f32 v107, v107, v12
    v_cvt_pk_bf16_f32 v128, v104, v105
    v_and_b32 v105, 0xffff0000, v128
    v_lshlrev_b32 v104, 16, v128
    v_cvt_pk_bf16_f32 v129, v106, v107
    v_and_b32 v107, 0xffff0000, v129
    v_lshlrev_b32 v106, 16, v129
    v_mul_f32 v104, v104, v13
    v_mul_f32 v105, v105, v13
    v_mul_f32 v106, v106, v13
    v_mul_f32 v107, v107, v13
    v_cvt_pk_bf16_f32 v128, v104, v105
    v_and_b32 v105, 0xffff0000, v128
    v_lshlrev_b32 v104, 16, v128
    v_cvt_pk_bf16_f32 v129, v106, v107
    v_and_b32 v107, 0xffff0000, v129
    v_lshlrev_b32 v106, 16, v129
    v_mul_f32 v104, v104, v148
    v_mul_f32 v105, v105, v149
    v_mul_f32 v106, v106, v150
    v_mul_f32 v107, v107, v151
    v_cvt_pk_bf16_f32 v128, v104, v105
    v_and_b32 v105, 0xffff0000, v128
    v_lshlrev_b32 v104, 16, v128
    v_cvt_pk_bf16_f32 v129, v106, v107
    v_and_b32 v107, 0xffff0000, v129
    v_lshlrev_b32 v106, 16, v129
    v_add_f32 v104, v104, v144
    v_add_f32 v105, v105, v145
    v_add_f32 v106, v106, v146
    v_add_f32 v107, v107, v147
    v_cvt_pk_bf16_f32 v128, v104, v105
    v_cvt_pk_bf16_f32 v129, v106, v107
    ds_write_b64 v16, v[128:129]
    s_waitcnt lgkmcnt(0)
    s_barrier
    ds_read_b128 v[128:131], v18 offset:0
    ds_read_b128 v[132:135], v18 offset:64
    ds_read_b128 v[136:139], v18 offset:128
    ds_read_b128 v[140:143], v18 offset:192
    ds_read_b128 v[144:147], v18 offset:256
    ds_read_b128 v[148:151], v18 offset:320
    ds_read_b128 v[152:155], v18 offset:384
    ds_read_b128 v[156:159], v18 offset:448
    s_waitcnt lgkmcnt(7)
    v_mfma_f32_16x16x32_bf16 v[124:127], v[128:131], v[40:43], 0
    s_waitcnt lgkmcnt(6)
    v_mfma_f32_16x16x32_bf16 v[124:127], v[132:135], v[44:47], v[124:127]
    s_waitcnt lgkmcnt(5)
    v_mfma_f32_16x16x32_bf16 v[124:127], v[136:139], v[48:51], v[124:127]
    s_waitcnt lgkmcnt(4)
    v_mfma_f32_16x16x32_bf16 v[124:127], v[140:143], v[52:55], v[124:127]
    s_waitcnt lgkmcnt(3)
    v_mfma_f32_16x16x32_bf16 v[124:127], v[144:147], v[56:59], v[124:127]
    s_waitcnt lgkmcnt(2)
    v_mfma_f32_16x16x32_bf16 v[124:127], v[148:151], v[60:63], v[124:127]
    s_waitcnt lgkmcnt(1)
    v_mfma_f32_16x16x32_bf16 v[124:127], v[152:155], v[64:67], v[124:127]
    s_waitcnt lgkmcnt(0)
    v_mfma_f32_16x16x32_bf16 v[124:127], v[156:159], v[68:71], v[124:127]
    s_nop 7
    ds_write_b32 v19, v124
    s_mov_b32 s38, 0xbfb8aa3b
    s_waitcnt lgkmcnt(0)
    s_barrier
    s_cmp_lt_u32 s33, 2
    s_cbranch_scc0 L_F_act_skip
    ds_read_b32 v128, v20
    ds_read_b32 v129, v20 offset:1024
    ds_read_b32 v130, v20 offset:512
    ds_read_b32 v131, v20 offset:1536
    s_waitcnt lgkmcnt(0)
    v_add_f32 v128, v128, v129
    v_add_f32 v130, v130, v131
    v_cvt_pk_bf16_f32 v129, v128, v130
    v_and_b32 v130, 0xffff0000, v129
    v_lshlrev_b32 v128, 16, v129
    v_mul_f32 v128, s38, v128
    v_exp_f32 v128, v128
    s_nop 0
    v_add_f32 v128, 1.0, v128
    v_rcp_f32 v128, v128
    s_nop 0
    v_cvt_pk_bf16_f32 v128, v128, v128
    v_lshlrev_b32 v128, 16, v128
    v_mul_f32 v128, v128, v130
    v_cvt_pk_bf16_f32 v128, v128, v128
    ds_write_b16 v21, v128
L_F_act_skip:
    s_waitcnt lgkmcnt(0)
    s_barrier
    ds_read_b128 v[128:131], v22
    v_mov_b32 v137, s32
    s_waitcnt lgkmcnt(0)
    v_mfma_f32_16x16x32_bf16 v[40:43], v[128:131], v[72:75], 0
    v_mfma_f32_16x16x32_bf16 v[44:47], v[128:131], v[76:79], 0
    v_mfma_f32_16x16x32_bf16 v[48:51], v[128:131], v[80:83], 0
    v_mfma_f32_16x16x32_bf16 v[52:55], v[128:131], v[84:87], 0
    v_mov_b32 v139, s32
    s_nop 4
    v_cvt_pk_bf16_f32 v136, v40, v44
    s_nop 0
    v_cvt_pk_bf16_f32 v138, v48, v52
    buffer_store_dwordx4 v[136:139], v23, s[40:43], s67 offen sc1
L_na_done:
L_end:
    s_endpgm
L_code_end:
.section .rodata,"a"
.p2align 6
.amdhsa_kernel adaLN_cond__sliding_block_cached__glu_gated_glu__decode_kernel
  .amdhsa_next_free_vgpr 168
  .amdhsa_next_free_sgpr 102
  .amdhsa_accum_offset 168
  .amdhsa_group_segment_fixed_size 0
  .amdhsa_kernarg_size 112
  .amdhsa_user_sgpr_count 2
  .amdhsa_user_sgpr_kernarg_segment_ptr 1
  .amdhsa_system_sgpr_workgroup_id_x 1
  .amdhsa_float_denorm_mode_32 3
.end_amdhsa_kernel
```
